```python
import torch

def _softmax(x, axis=-1):
    return torch.softmax(x, dim=axis)
def _gelu(x):
    return torch.nn.functional.gelu(x, approximate="tanh")
def _silu(x):
    return torch.nn.functional.silu(x)
def _sigmoid(x):
    return torch.sigmoid(x)
def _layernorm(x, axis=-1, eps=1e-5):
    m = x.mean(dim=axis, keepdim=True)
    v = x.var(dim=axis, keepdim=True, unbiased=False)
    return (x - m) / torch.sqrt(v + eps)
def _scatter_add(tgt, idx, src, axis=0):
    return tgt.clone().index_add_(axis, idx, src)
def _segment_sum(src, seg, n):
    out = torch.zeros((n,) + src.shape[1:], dtype=src.dtype)
    return out.index_add_(0, seg, src)
def _pad(x, pw):
    flat = tuple(v for pair in reversed(pw) for v in pair)
    return torch.nn.functional.pad(x, flat)

kernel_name = 'standalone__gqa_block_cached__near_ridge'

def setup_inputs():

    _w = (lambda a: (lambda t: t.to(torch.bfloat16) if t.is_floating_point() else t)(torch.as_tensor(a)))
    B, Sq, D = 8, 80, 512
    Hq, Hkv, Sk, Dh = 32, 8, 2048, 128
    assert Hq % Hkv == 0, (Hq, Hkv)
    return {
        "x": _w((lambda *s: torch.randn(*s, dtype=torch.bfloat16) * 0.8)(B, Sq, D)),
        "k_cache": _w((lambda *s: torch.randn(*s, dtype=torch.bfloat16) * 0.8)(B, Hkv, Sk, Dh)),
        "v_cache": _w((lambda *s: torch.randn(*s, dtype=torch.bfloat16) * 0.05)(B, Hkv, Sk, Dh)),
        "wq": _w((lambda *s: torch.randn(*s, dtype=torch.bfloat16) * 0.8)(D, Hq * Dh) * (D ** -0.5)),
        "wo": _w((lambda *s: torch.randn(*s, dtype=torch.bfloat16) * 0.05)(Hq * Dh, D) * ((Hq * Dh) ** -0.5)),
    }

def reference(x, k_cache, v_cache, wq, wo):
    B, Sq, D = x.shape
    Hq, Dh = 32, 128
    Hkv = k_cache.shape[1]
    rep = Hq // Hkv
    q = (lambda x, *d: x.permute(*d))((x @ wq).reshape(B, Sq, Hq, Dh), 0, 2, 1, 3)
    k = (lambda x, n, axis: torch.repeat_interleave(x, n, dim=axis))(k_cache, rep, axis=1)
    v = (lambda x, n, axis: torch.repeat_interleave(x, n, dim=axis))(v_cache, rep, axis=1)
    scores = torch.einsum("bhqd,bhkd->bhqk", q, k) * (Dh ** -0.5)
    p = _softmax(scores, axis=-1)
    o = torch.einsum("bhqk,bhkd->bhqd", p, v)
    return (lambda x, *d: x.permute(*d))(o, 0, 2, 1, 3).reshape(B, Sq, Hq * Dh) @ wo
```

```asm
; @launch grid=(256,1,1) block=(256,1,1) lds=163840
.amdgcn_target "amdgcn-amd-amdhsa--gfx950"
.text
.globl standalone__gqa_block_cached__near_ridge_kernel
.p2align 8
.type standalone__gqa_block_cached__near_ridge_kernel,@function
standalone__gqa_block_cached__near_ridge_kernel:
    s_cmp_ge_u32 s2, 256
    s_cbranch_scc1 L_end
    s_load_dwordx16 s[64:79], s[0:1], 0
    s_getpc_b64 s[30:31]
L_pc:
    s_lshr_b32 s60, s2, 3
    v_lshrrev_b32 v2, 6, v0
    v_and_b32 v1, 63, v0
    v_lshl_add_u32 v2, s60, 2, v2
    v_lshl_add_u32 v2, v2, 2, v1
    v_lshlrev_b32 v2, 7, v2
    v_mov_b32 v5, s31
    v_add_co_u32 v4, vcc, s30, v2
    s_nop 1
    v_addc_co_u32 v5, vcc, 0, v5, vcc
    v_cmp_gt_u32 vcc, 4, v1
    s_mov_b32 s60, L_text_main_end-L_pc
    v_cmp_gt_u32 s[62:63], s60, v2
    s_nop 1
    s_and_b64 vcc, vcc, s[62:63]
    s_and_saveexec_b64 s[62:63], vcc
    s_cbranch_execz L_nocpf
    global_load_dword v243, v[4:5], off
L_nocpf:
    s_mov_b64 exec, s[62:63]
    v_lshrrev_b32 v2, 6, v0
    v_and_b32 v1, 63, v0
    s_and_b32 s24, s2, 7
    s_lshr_b32 s30, s2, 3
    v_readfirstlane_b32 s27, v2
    s_lshr_b32 s25, s30, 2
    s_and_b32 s26, s30, 3
    s_lshl_b32 s28, s24, 2
    s_add_u32 s28, s28, s26
    v_and_b32 v3, 15, v1
    v_lshrrev_b32 v4, 4, v1
    v_bfe_u32 v5, v1, 2, 2
    v_and_b32 v6, 3, v1
    s_lshl_b32 s39, s27, 10
    s_add_u32 s42, s25, s26
    s_and_b32 s42, s42, 3
    s_lshl_b32 s30, s27, 2
    v_add_u32 v8, s30, v4
    v_xor_b32 v9, v3, v8
    v_lshlrev_b32 v9, 4, v9
    v_lshl_add_u32 v84, v8, 10, v9
    v_lshlrev_b32 v9, 2, v4
    v_xor_b32 v9, v3, v9
    v_lshlrev_b32 v9, 4, v9
    v_lshl_add_u32 v92, v8, 13, v9
    s_mul_i32 s31, s25, 81920
    v_add_u32 v85, 16384, v84
    v_add_u32 v86, 32768, v84
    v_add_u32 v87, 49152, v84
    v_add_u32 v88, 65536, v84
    v_add_u32 v93, 131072, v92
    v_add_u32 v94, 262144, v92
    v_add_u32 v95, 393216, v92
    s_lshl_b32 s61, s28, 8
    s_lshl_b32 s62, s42, 1
    s_add_u32 s60, s62, 0
    s_and_b32 s60, s60, 7
    s_lshl_b32 s60, s60, 19
    s_add_u32 s100, s60, s61
    s_add_u32 s60, s62, 1
    s_and_b32 s60, s60, 7
    s_lshl_b32 s60, s60, 19
    s_add_u32 s101, s60, s61
    s_add_u32 s60, s62, 2
    s_and_b32 s60, s60, 7
    s_lshl_b32 s60, s60, 19
    s_add_u32 s97, s60, s61
    s_add_u32 s60, s62, 3
    s_and_b32 s60, s60, 7
    s_lshl_b32 s60, s60, 19
    s_add_u32 s96, s60, s61
    s_add_u32 s60, s62, 4
    s_and_b32 s60, s60, 7
    s_lshl_b32 s60, s60, 19
    s_add_u32 s95, s60, s61
    s_add_u32 s60, s62, 5
    s_and_b32 s60, s60, 7
    s_lshl_b32 s60, s60, 19
    s_add_u32 s94, s60, s61
    s_add_u32 s60, s62, 6
    s_and_b32 s60, s60, 7
    s_lshl_b32 s60, s60, 19
    s_add_u32 s93, s60, s61
    s_add_u32 s60, s62, 7
    s_and_b32 s60, s60, 7
    s_lshl_b32 s60, s60, 19
    s_add_u32 s92, s60, s61
    s_add_u32 s60, s42, 0
    s_and_b32 s60, s60, 3
    s_lshl_b32 s60, s60, 8
    s_add_u32 s88, s60, s31
    s_add_u32 s60, s42, 1
    s_and_b32 s60, s60, 3
    s_lshl_b32 s60, s60, 8
    s_add_u32 s89, s60, s31
    s_add_u32 s60, s42, 2
    s_and_b32 s60, s60, 3
    s_lshl_b32 s60, s60, 8
    s_add_u32 s90, s60, s31
    s_add_u32 s60, s42, 3
    s_and_b32 s60, s60, 3
    s_lshl_b32 s60, s60, 8
    s_add_u32 s91, s60, s31
    s_waitcnt lgkmcnt(0)
    s_mov_b32 s4, s64
    s_mov_b32 s5, s65
    s_mov_b32 s6, 655360
    s_mov_b32 s7, 0x00020000
    s_mov_b32 s16, s70
    s_mov_b32 s17, s71
    s_mov_b32 s18, 4194304
    s_mov_b32 s19, 0x00020000
    s_add_u32 m0, s39, 90112
    s_nop 0
    buffer_load_dwordx4 v92, s[16:19], s100 offen lds
    s_add_u32 m0, s39, 94208
    s_nop 0
    buffer_load_dwordx4 v93, s[16:19], s100 offen lds
    s_add_u32 m0, s39, 122880
    s_nop 0
    buffer_load_dwordx4 v94, s[16:19], s100 offen lds
    s_add_u32 m0, s39, 126976
    s_nop 0
    buffer_load_dwordx4 v95, s[16:19], s100 offen lds
    s_add_u32 m0, s39, 16384
    s_nop 0
    buffer_load_dwordx4 v84, s[4:7], s88 offen lds
    s_add_u32 m0, s39, 20480
    s_nop 0
    buffer_load_dwordx4 v85, s[4:7], s88 offen lds
    s_add_u32 m0, s39, 49152
    s_nop 0
    buffer_load_dwordx4 v86, s[4:7], s88 offen lds
    s_add_u32 m0, s39, 53248
    s_nop 0
    buffer_load_dwordx4 v87, s[4:7], s88 offen lds
    s_add_u32 m0, s39, 81920
    s_nop 0
    buffer_load_dwordx4 v88, s[4:7], s88 offen lds
    s_lshl_b32 s29, s27, 15
    s_lshl_b32 s34, s27, 13
    s_mov_b32 s43, 0
    s_lshl_b32 s30, s25, 3
    s_add_u32 s30, s30, s24
    s_lshl_b32 s81, s30, 7
    s_lshl_b32 s30, s30, 19
    s_add_u32 s8, s66, s30
    s_addc_u32 s9, s67, 0
    s_mov_b32 s10, 0x80000
    s_mov_b32 s11, 0x00020000
    s_add_u32 s12, s68, s30
    s_addc_u32 s13, s69, 0
    s_mov_b32 s14, 0x80000
    s_mov_b32 s15, 0x00020000
    s_add_u32 s20, s78, 0
    s_addc_u32 s21, s79, 0
    s_mov_b32 s22, 5242880
    s_mov_b32 s23, 0x00020000
    s_add_u32 s48, s78, 8388608
    s_addc_u32 s49, s79, 0
    s_mov_b32 s50, 5242880
    s_mov_b32 s51, 0x00020000
    s_add_u32 s52, s78, 25165824
    s_addc_u32 s53, s79, 0
    s_mov_b32 s54, 16384
    s_mov_b32 s55, 0x00020000
    s_mov_b32 s44, s72
    s_mov_b32 s45, s73
    s_mov_b32 s46, 4194304
    s_mov_b32 s47, 0x00020000
    s_mov_b32 s56, s76
    s_mov_b32 s57, s77
    s_mov_b32 s58, 256
    s_mov_b32 s59, 0x00020000
    s_mov_b32 s84, s74
    s_mov_b32 s85, s75
    s_mov_b32 s86, 655360
    s_mov_b32 s87, 0x00020000
    s_lshl_b32 s30, s25, 2
    s_add_u32 s30, s30, s26
    s_add_u32 m0, s39, 131072
    s_nop 0
    buffer_load_dwordx4 v92, s[16:19], s101 offen lds
    s_lshl_b32 s82, s30, 7
    s_add_u32 s82, s82, 8192
    s_lshl_b32 s80, s24, 19
    s_lshl_b32 s30, s30, 14
    s_add_u32 s80, s80, s30
    s_lshl_b32 s30, s27, 12
    s_add_u32 s80, s80, s30
    v_lshlrev_b32 v38, 4, v1
    v_xor_b32 v7, v4, v3
    v_lshlrev_b32 v7, 4, v7
    v_lshl_add_u32 v7, v3, 8, v7
    s_mov_b32 s33, s2
    s_and_b32 s60, s25, 3
    s_lshl_b32 s60, s60, 2
    s_add_u32 s60, s60, s26
    s_mov_b32 s2, 0x76543210
    s_mov_b32 s3, 0xfedcba98
    s_cmp_eq_u32 s60, 1
    s_cselect_b32 s2, 0x87614320, s2
    s_cselect_b32 s3, 0xdfe9cba5, s3
    s_cmp_eq_u32 s60, 2
    s_cselect_b32 s2, 0x58721430, s2
    s_cselect_b32 s3, 0xedfa9cb6, s3
    s_cmp_eq_u32 s60, 3
    s_cselect_b32 s2, 0x65832140, s2
    s_cselect_b32 s3, 0xfedba9c7, s3
    s_cmp_eq_u32 s60, 4
    s_cselect_b32 s2, 0x76543210, s2
    s_cselect_b32 s3, 0xfedcba98, s3
    s_cmp_eq_u32 s60, 5
    s_cselect_b32 s2, 0x87254301, s2
    s_cselect_b32 s3, 0xefadcb69, s3
    s_cmp_eq_u32 s60, 6
    s_cselect_b32 s2, 0x98325410, s2
    s_cselect_b32 s3, 0xfebadc76, s3
    s_cmp_eq_u32 s60, 7
    s_cselect_b32 s2, 0x69432501, s2
    s_cselect_b32 s3, 0xefcbad87, s3
    s_cmp_eq_u32 s60, 8
    s_cselect_b32 s2, 0x76543210, s2
    s_cselect_b32 s3, 0xfedcba98, s3
    s_add_u32 m0, s39, 135168
    s_nop 0
    buffer_load_dwordx4 v93, s[16:19], s101 offen lds
    s_cmp_eq_u32 s60, 9
    s_cselect_b32 s2, 0x83654021, s2
    s_cselect_b32 s3, 0xfbedc7a9, s3
    s_cmp_eq_u32 s60, 10
    s_cselect_b32 s2, 0x94365102, s2
    s_cselect_b32 s3, 0xfcbed87a, s3
    s_cmp_eq_u32 s60, 11
    s_cselect_b32 s2, 0xa5436210, s2
    s_cselect_b32 s3, 0xfdcbe987, s3
    s_cmp_eq_u32 s60, 12
    s_cselect_b32 s2, 0x76543210, s2
    s_cselect_b32 s3, 0xfedcba98, s3
    s_cmp_eq_u32 s60, 13
    s_cselect_b32 s2, 0x47650321, s2
    s_cselect_b32 s3, 0xcfed8ba9, s3
    s_cmp_eq_u32 s60, 14
    s_cselect_b32 s2, 0x54761032, s2
    s_cselect_b32 s3, 0xdcfe98ba, s3
    s_cmp_eq_u32 s60, 15
    s_cselect_b32 s2, 0x65472103, s2
    s_cselect_b32 s3, 0xedcfa98b, s3
    s_mov_b32 s32, 0
    v_xor_b32 v244, 0, v7
    v_add_u32 v248, 0x10000, v244
    v_add_u32 v10, s29, v244
    v_xor_b32 v245, 64, v7
    v_add_u32 v249, 0x10000, v245
    v_add_u32 v11, s29, v245
    v_xor_b32 v246, 128, v7
    v_add_u32 v250, 0x10000, v246
    v_add_u32 v12, s29, v246
    v_xor_b32 v247, 192, v7
    v_add_u32 v251, 0x10000, v247
    v_add_u32 v13, s29, v247
    v_lshl_add_u32 v8, v4, 3, v5
    s_lshl_b32 s30, s27, 2
    v_add_u32 v9, s30, v6
    v_lshlrev_b32 v2, 2, v5
    v_xor_b32 v9, v9, v2
    v_lshlrev_b32 v9, 4, v9
    v_lshl_add_u32 v9, v8, 8, v9
    s_add_u32 m0, s39, 139264
    s_nop 0
    buffer_load_dwordx4 v94, s[16:19], s101 offen lds
    v_mov_b32 v252, v9
    v_add_u32 v253, 0x10000, v9
    v_add_u32 v254, 0x20000, v9
    v_lshl_add_u32 v8, v4, 2, v5
    v_and_b32 v9, 7, v8
    v_lshlrev_b32 v9, 5, v9
    v_lshl_add_u32 v9, v8, 8, v9
    v_lshl_add_u32 v9, v6, 3, v9
    s_lshl_b32 s61, s27, 1
    s_add_u32 s61, s61, 0
    s_and_b32 s61, s61, 7
    s_lshl_b32 s61, s61, 5
    v_xor_b32 v14, s61, v9
    v_add_u32 v14, s29, v14
    s_lshl_b32 s61, s27, 1
    s_add_u32 s61, s61, 1
    s_and_b32 s61, s61, 7
    s_lshl_b32 s61, s61, 5
    v_xor_b32 v15, s61, v9
    v_add_u32 v15, s29, v15
    s_lshl_b32 s61, s27, 1
    s_add_u32 s61, s61, 2
    s_and_b32 s61, s61, 7
    s_lshl_b32 s61, s61, 5
    v_xor_b32 v16, s61, v9
    v_add_u32 v16, s29, v16
    s_lshl_b32 s61, s27, 1
    s_add_u32 s61, s61, 3
    s_and_b32 s61, s61, 7
    s_lshl_b32 s61, s61, 5
    v_xor_b32 v17, s61, v9
    v_add_u32 v17, s29, v17
    s_lshl_b32 s61, s27, 1
    s_add_u32 s61, s61, 4
    s_and_b32 s61, s61, 7
    s_lshl_b32 s61, s61, 5
    v_xor_b32 v18, s61, v9
    v_add_u32 v18, s29, v18
    s_lshl_b32 s61, s27, 1
    s_add_u32 s61, s61, 5
    s_and_b32 s61, s61, 7
    s_add_u32 m0, s39, 143360
    s_nop 0
    buffer_load_dwordx4 v95, s[16:19], s101 offen lds
    s_lshl_b32 s61, s61, 5
    v_xor_b32 v19, s61, v9
    v_add_u32 v19, s29, v19
    s_lshl_b32 s61, s27, 1
    s_add_u32 s61, s61, 6
    s_and_b32 s61, s61, 7
    s_lshl_b32 s61, s61, 5
    v_xor_b32 v20, s61, v9
    v_add_u32 v20, s29, v20
    s_lshl_b32 s61, s27, 1
    s_add_u32 s61, s61, 7
    s_and_b32 s61, s61, 7
    s_lshl_b32 s61, s61, 5
    v_xor_b32 v21, s61, v9
    v_add_u32 v21, s29, v21
    v_xor_b32 v9, v3, v4
    v_lshlrev_b32 v9, 4, v9
    v_lshl_add_u32 v9, v4, 8, v9
    v_xor_b32 v22, 0, v9
    v_xor_b32 v23, 64, v9
    v_xor_b32 v24, 128, v9
    v_xor_b32 v25, 192, v9
    v_lshlrev_b32 v9, 1, v4
    v_xor_b32 v9, v3, v9
    v_lshlrev_b32 v9, 4, v9
    v_lshl_add_u32 v26, v4, 8, v9
    v_xor_b32 v27, 128, v26
    v_mov_b32 v116, 0
    v_mov_b32 v117, 0
    v_mov_b32 v118, 0
    v_mov_b32 v119, 0
    s_nop 1
    v_mfma_f32_32x32x16_bf16 a[0:15], v[116:119], v[116:119], 0
    v_mfma_f32_32x32x16_bf16 a[16:31], v[116:119], v[116:119], 0
    v_mfma_f32_32x32x16_bf16 a[32:47], v[116:119], v[116:119], 0
    v_mfma_f32_32x32x16_bf16 a[48:63], v[116:119], v[116:119], 0
    v_mfma_f32_32x32x16_bf16 a[64:79], v[116:119], v[116:119], 0
    v_mfma_f32_32x32x16_bf16 a[80:95], v[116:119], v[116:119], 0
    v_mfma_f32_32x32x16_bf16 a[96:111], v[116:119], v[116:119], 0
    v_mfma_f32_32x32x16_bf16 a[112:127], v[116:119], v[116:119], 0
    v_mfma_f32_32x32x16_bf16 a[128:143], v[116:119], v[116:119], 0
    v_mfma_f32_32x32x16_bf16 a[144:159], v[116:119], v[116:119], 0
    s_cmp_eq_u32 s27, 0
    s_cbranch_scc0 L_noclr
    s_lshl_b32 s60, s26, 2
    s_add_u32 s60, s60, s81
    s_lshl_b32 s61, s24, 2
    s_add_u32 s61, s61, s82
    v_mov_b32 v2, 0
    s_mov_b64 exec, 1
    buffer_store_dword v2, off, s[52:55], s60 sc1
    buffer_store_dword v2, off, s[52:55], s61 sc1
    s_mov_b64 exec, -1
L_noclr:
    s_waitcnt vmcnt(4)
    s_barrier
    s_cmp_ge_u32 s27, 2
    s_cbranch_scc1 L_qp2
    ds_read_b64_tr_b16 v[188:189], v253 offset:24576
    ds_read_b64_tr_b16 v[190:191], v253 offset:25600
    ds_read_b128 v[204:207], v244 offset:16384
    ds_read_b64_tr_b16 v[192:193], v253 offset:24584
    ds_read_b64_tr_b16 v[194:195], v253 offset:25608
    ds_read_b128 v[208:211], v244 offset:20480
    ds_read_b128 v[212:215], v244 offset:49152
    ds_read_b128 v[216:219], v244 offset:53248
    ds_read_b128 v[220:223], v248 offset:16384
    s_waitcnt lgkmcnt(0)
    v_mfma_f32_16x16x32_bf16 v[148:151], v[188:191], v[204:207], 0
    ds_read_b64_tr_b16 v[196:197], v253 offset:57344
    ds_read_b64_tr_b16 v[198:199], v253 offset:58368
    v_mfma_f32_16x16x32_bf16 v[168:171], v[192:195], v[204:207], 0
    ds_read_b128 v[224:227], v245 offset:16384
    ds_read_b64_tr_b16 v[200:201], v253 offset:57352
    v_mfma_f32_16x16x32_bf16 v[152:155], v[188:191], v[208:211], 0
    ds_read_b64_tr_b16 v[202:203], v253 offset:58376
    ds_read_b128 v[228:231], v245 offset:20480
    v_mfma_f32_16x16x32_bf16 v[172:175], v[192:195], v[208:211], 0
    ds_read_b128 v[232:235], v245 offset:49152
    ds_read_b128 v[236:239], v245 offset:53248
    v_mfma_f32_16x16x32_bf16 v[156:159], v[188:191], v[212:215], 0
    ds_read_b128 v[240:243], v249 offset:16384
    s_add_u32 m0, s39, 86016
    s_nop 0
    buffer_load_dwordx4 v84, s[4:7], s89 offen lds
    s_add_u32 m0, s39, 114688
    s_nop 0
    buffer_load_dwordx4 v85, s[4:7], s89 offen lds
    v_mfma_f32_16x16x32_bf16 v[176:179], v[192:195], v[212:215], 0
    s_add_u32 m0, s39, 118784
    s_nop 0
    buffer_load_dwordx4 v86, s[4:7], s89 offen lds
    s_add_u32 m0, s39, 8192
    s_nop 0
    buffer_load_dwordx4 v87, s[4:7], s89 offen lds
    v_mfma_f32_16x16x32_bf16 v[160:163], v[188:191], v[216:219], 0
    s_add_u32 m0, s39, 12288
    s_nop 0
    buffer_load_dwordx4 v88, s[4:7], s89 offen lds
    s_add_u32 m0, s39, 147456
    s_nop 0
    buffer_load_dwordx4 v92, s[16:19], s97 offen lds
    v_mfma_f32_16x16x32_bf16 v[180:183], v[192:195], v[216:219], 0
    s_add_u32 m0, s39, 151552
    s_nop 0
    buffer_load_dwordx4 v93, s[16:19], s97 offen lds
    v_mfma_f32_16x16x32_bf16 v[164:167], v[188:191], v[220:223], 0
    s_add_u32 m0, s39, 155648
    s_nop 0
    buffer_load_dwordx4 v94, s[16:19], s97 offen lds
    v_mfma_f32_16x16x32_bf16 v[184:187], v[192:195], v[220:223], 0
    s_add_u32 m0, s39, 159744
    s_nop 0
    buffer_load_dwordx4 v95, s[16:19], s97 offen lds
    s_waitcnt lgkmcnt(0)
    s_waitcnt vmcnt(9)
    s_barrier
    v_mfma_f32_16x16x32_bf16 v[148:151], v[196:199], v[224:227], v[148:151]
    ds_read_b64_tr_b16 v[188:189], v254 offset:0
    ds_read_b64_tr_b16 v[190:191], v254 offset:1024
    v_mfma_f32_16x16x32_bf16 v[168:171], v[200:203], v[224:227], v[168:171]
    ds_read_b128 v[204:207], v246 offset:16384
    ds_read_b64_tr_b16 v[192:193], v254 offset:8
    v_mfma_f32_16x16x32_bf16 v[152:155], v[196:199], v[228:231], v[152:155]
    ds_read_b64_tr_b16 v[194:195], v254 offset:1032
    ds_read_b128 v[208:211], v246 offset:20480
    v_mfma_f32_16x16x32_bf16 v[172:175], v[200:203], v[228:231], v[172:175]
    ds_read_b128 v[212:215], v246 offset:49152
    ds_read_b128 v[216:219], v246 offset:53248
    v_mfma_f32_16x16x32_bf16 v[156:159], v[196:199], v[232:235], v[156:159]
    ds_read_b128 v[220:223], v250 offset:16384
    s_add_u32 m0, s39, 0
    s_nop 0
    buffer_load_dwordx4 v92, s[16:19], s96 offen lds
    s_add_u32 m0, s39, 4096
    s_nop 0
    buffer_load_dwordx4 v93, s[16:19], s96 offen lds
    v_mfma_f32_16x16x32_bf16 v[176:179], v[200:203], v[232:235], v[176:179]
    s_add_u32 m0, s39, 32768
    s_nop 0
    buffer_load_dwordx4 v94, s[16:19], s96 offen lds
    s_add_u32 m0, s39, 36864
    s_nop 0
    buffer_load_dwordx4 v95, s[16:19], s96 offen lds
    v_mfma_f32_16x16x32_bf16 v[160:163], v[196:199], v[236:239], v[160:163]
    s_add_u32 m0, s39, 65536
    s_nop 0
    buffer_load_dwordx4 v92, s[16:19], s95 offen lds
    v_mfma_f32_16x16x32_bf16 v[180:183], v[200:203], v[236:239], v[180:183]
    s_add_u32 m0, s39, 69632
    s_nop 0
    buffer_load_dwordx4 v93, s[16:19], s95 offen lds
    v_mfma_f32_16x16x32_bf16 v[164:167], v[196:199], v[240:243], v[164:167]
    s_add_u32 m0, s39, 98304
    s_nop 0
    buffer_load_dwordx4 v94, s[16:19], s95 offen lds
    v_mfma_f32_16x16x32_bf16 v[184:187], v[200:203], v[240:243], v[184:187]
    s_add_u32 m0, s39, 102400
    s_nop 0
    buffer_load_dwordx4 v95, s[16:19], s95 offen lds
    s_waitcnt lgkmcnt(0)
    v_mfma_f32_16x16x32_bf16 v[148:151], v[188:191], v[204:207], v[148:151]
    ds_read_b64_tr_b16 v[196:197], v254 offset:8192
    ds_read_b64_tr_b16 v[198:199], v254 offset:9216
    v_mfma_f32_16x16x32_bf16 v[168:171], v[192:195], v[204:207], v[168:171]
    ds_read_b128 v[224:227], v247 offset:16384
    ds_read_b64_tr_b16 v[200:201], v254 offset:8200
    v_mfma_f32_16x16x32_bf16 v[152:155], v[188:191], v[208:211], v[152:155]
    ds_read_b64_tr_b16 v[202:203], v254 offset:9224
    ds_read_b128 v[228:231], v247 offset:20480
    v_mfma_f32_16x16x32_bf16 v[172:175], v[192:195], v[208:211], v[172:175]
    ds_read_b128 v[232:235], v247 offset:49152
    ds_read_b128 v[236:239], v247 offset:53248
    v_mfma_f32_16x16x32_bf16 v[156:159], v[188:191], v[212:215], v[156:159]
    ds_read_b128 v[240:243], v251 offset:16384
    v_mfma_f32_16x16x32_bf16 v[176:179], v[192:195], v[212:215], v[176:179]
    v_mfma_f32_16x16x32_bf16 v[160:163], v[188:191], v[216:219], v[160:163]
    v_mfma_f32_16x16x32_bf16 v[180:183], v[192:195], v[216:219], v[180:183]
    v_mfma_f32_16x16x32_bf16 v[164:167], v[188:191], v[220:223], v[164:167]
    v_mfma_f32_16x16x32_bf16 v[184:187], v[192:195], v[220:223], v[184:187]
    s_waitcnt lgkmcnt(0)
    s_waitcnt vmcnt(8)
    s_barrier
    v_mfma_f32_16x16x32_bf16 v[148:151], v[196:199], v[224:227], v[148:151]
    ds_read_b64_tr_b16 v[188:189], v254 offset:16384
    ds_read_b64_tr_b16 v[190:191], v254 offset:17408
    v_mfma_f32_16x16x32_bf16 v[168:171], v[200:203], v[224:227], v[168:171]
    ds_read_b128 v[204:207], v248 offset:20480
    ds_read_b64_tr_b16 v[192:193], v254 offset:16392
    v_mfma_f32_16x16x32_bf16 v[152:155], v[196:199], v[228:231], v[152:155]
    ds_read_b64_tr_b16 v[194:195], v254 offset:17416
    ds_read_b128 v[208:211], v248 offset:49152
    v_mfma_f32_16x16x32_bf16 v[172:175], v[200:203], v[228:231], v[172:175]
    ds_read_b128 v[212:215], v248 offset:53248
    ds_read_b128 v[216:219], v244 offset:8192
    v_mfma_f32_16x16x32_bf16 v[156:159], v[196:199], v[232:235], v[156:159]
    ds_read_b128 v[220:223], v244 offset:12288
    s_add_u32 m0, s39, 40960
    s_nop 0
    buffer_load_dwordx4 v84, s[4:7], s90 offen lds
    s_add_u32 m0, s39, 45056
    s_nop 0
    buffer_load_dwordx4 v85, s[4:7], s90 offen lds
    v_mfma_f32_16x16x32_bf16 v[176:179], v[200:203], v[232:235], v[176:179]
    s_add_u32 m0, s39, 73728
    s_nop 0
    buffer_load_dwordx4 v86, s[4:7], s90 offen lds
    s_add_u32 m0, s39, 77824
    s_nop 0
    buffer_load_dwordx4 v87, s[4:7], s90 offen lds
    v_mfma_f32_16x16x32_bf16 v[160:163], v[196:199], v[236:239], v[160:163]
    s_add_u32 m0, s39, 106496
    s_nop 0
    buffer_load_dwordx4 v88, s[4:7], s90 offen lds
    s_add_u32 m0, s39, 90112
    s_nop 0
    buffer_load_dwordx4 v92, s[16:19], s94 offen lds
    v_mfma_f32_16x16x32_bf16 v[180:183], v[200:203], v[236:239], v[180:183]
    s_add_u32 m0, s39, 94208
    s_nop 0
    buffer_load_dwordx4 v93, s[16:19], s94 offen lds
    v_mfma_f32_16x16x32_bf16 v[164:167], v[196:199], v[240:243], v[164:167]
    s_add_u32 m0, s39, 122880
    s_nop 0
    buffer_load_dwordx4 v94, s[16:19], s94 offen lds
    v_mfma_f32_16x16x32_bf16 v[184:187], v[200:203], v[240:243], v[184:187]
    s_add_u32 m0, s39, 126976
    s_nop 0
    buffer_load_dwordx4 v95, s[16:19], s94 offen lds
    s_waitcnt lgkmcnt(0)
    v_mfma_f32_16x16x32_bf16 v[148:151], v[188:191], v[204:207], v[148:151]
    ds_read_b64_tr_b16 v[196:197], v254 offset:24576
    ds_read_b64_tr_b16 v[198:199], v254 offset:25600
    v_mfma_f32_16x16x32_bf16 v[168:171], v[192:195], v[204:207], v[168:171]
    ds_read_b128 v[224:227], v249 offset:20480
    ds_read_b64_tr_b16 v[200:201], v254 offset:24584
    v_mfma_f32_16x16x32_bf16 v[152:155], v[188:191], v[208:211], v[152:155]
    ds_read_b64_tr_b16 v[202:203], v254 offset:25608
    ds_read_b128 v[228:231], v249 offset:49152
    v_mfma_f32_16x16x32_bf16 v[172:175], v[192:195], v[208:211], v[172:175]
    ds_read_b128 v[232:235], v249 offset:53248
    ds_read_b128 v[236:239], v245 offset:8192
    v_mfma_f32_16x16x32_bf16 v[156:159], v[188:191], v[212:215], v[156:159]
    ds_read_b128 v[240:243], v245 offset:12288
    v_mfma_f32_16x16x32_bf16 v[176:179], v[192:195], v[212:215], v[176:179]
    v_mfma_f32_16x16x32_bf16 v[160:163], v[188:191], v[216:219], v[160:163]
    v_mfma_f32_16x16x32_bf16 v[180:183], v[192:195], v[216:219], v[180:183]
    v_mfma_f32_16x16x32_bf16 v[164:167], v[188:191], v[220:223], v[164:167]
    v_mfma_f32_16x16x32_bf16 v[184:187], v[192:195], v[220:223], v[184:187]
    s_waitcnt lgkmcnt(0)
    s_waitcnt vmcnt(13)
    s_barrier
    v_mfma_f32_16x16x32_bf16 v[148:151], v[196:199], v[224:227], v[148:151]
    ds_read_b64_tr_b16 v[188:189], v252 offset:0
    ds_read_b64_tr_b16 v[190:191], v252 offset:1024
    v_mfma_f32_16x16x32_bf16 v[168:171], v[200:203], v[224:227], v[168:171]
    ds_read_b128 v[204:207], v250 offset:20480
    ds_read_b64_tr_b16 v[192:193], v252 offset:8
    v_mfma_f32_16x16x32_bf16 v[152:155], v[196:199], v[228:231], v[152:155]
    ds_read_b64_tr_b16 v[194:195], v252 offset:1032
    ds_read_b128 v[208:211], v250 offset:49152
    v_mfma_f32_16x16x32_bf16 v[172:175], v[200:203], v[228:231], v[172:175]
    ds_read_b128 v[212:215], v250 offset:53248
    ds_read_b128 v[216:219], v246 offset:8192
    v_mfma_f32_16x16x32_bf16 v[156:159], v[196:199], v[232:235], v[156:159]
    ds_read_b128 v[220:223], v246 offset:12288
    s_add_u32 m0, s39, 131072
    s_nop 0
    buffer_load_dwordx4 v92, s[16:19], s93 offen lds
    s_add_u32 m0, s39, 135168
    s_nop 0
    buffer_load_dwordx4 v93, s[16:19], s93 offen lds
    v_mfma_f32_16x16x32_bf16 v[176:179], v[200:203], v[232:235], v[176:179]
    s_add_u32 m0, s39, 139264
    s_nop 0
    buffer_load_dwordx4 v94, s[16:19], s93 offen lds
    s_add_u32 m0, s39, 143360
    s_nop 0
    buffer_load_dwordx4 v95, s[16:19], s93 offen lds
    v_mfma_f32_16x16x32_bf16 v[160:163], v[196:199], v[236:239], v[160:163]
    s_add_u32 m0, s39, 110592
    s_nop 0
    buffer_load_dwordx4 v84, s[4:7], s91 offen lds
    s_add_u32 m0, s39, 24576
    s_nop 0
    buffer_load_dwordx4 v85, s[4:7], s91 offen lds
    v_mfma_f32_16x16x32_bf16 v[180:183], v[200:203], v[236:239], v[180:183]
    s_add_u32 m0, s39, 28672
    s_nop 0
    buffer_load_dwordx4 v86, s[4:7], s91 offen lds
    v_mfma_f32_16x16x32_bf16 v[164:167], v[196:199], v[240:243], v[164:167]
    s_add_u32 m0, s39, 57344
    s_nop 0
    buffer_load_dwordx4 v87, s[4:7], s91 offen lds
    v_mfma_f32_16x16x32_bf16 v[184:187], v[200:203], v[240:243], v[184:187]
    s_add_u32 m0, s39, 61440
    s_nop 0
    buffer_load_dwordx4 v88, s[4:7], s91 offen lds
    s_waitcnt lgkmcnt(0)
    v_mfma_f32_16x16x32_bf16 v[148:151], v[188:191], v[204:207], v[148:151]
    ds_read_b64_tr_b16 v[196:197], v252 offset:32768
    ds_read_b64_tr_b16 v[198:199], v252 offset:33792
    v_mfma_f32_16x16x32_bf16 v[168:171], v[192:195], v[204:207], v[168:171]
    ds_read_b128 v[224:227], v251 offset:20480
    ds_read_b64_tr_b16 v[200:201], v252 offset:32776
    v_mfma_f32_16x16x32_bf16 v[152:155], v[188:191], v[208:211], v[152:155]
    ds_read_b64_tr_b16 v[202:203], v252 offset:33800
    ds_read_b128 v[228:231], v251 offset:49152
    v_mfma_f32_16x16x32_bf16 v[172:175], v[192:195], v[208:211], v[172:175]
    ds_read_b128 v[232:235], v251 offset:53248
    ds_read_b128 v[236:239], v247 offset:8192
    v_mfma_f32_16x16x32_bf16 v[156:159], v[188:191], v[212:215], v[156:159]
    ds_read_b128 v[240:243], v247 offset:12288
    v_mfma_f32_16x16x32_bf16 v[176:179], v[192:195], v[212:215], v[176:179]
    v_mfma_f32_16x16x32_bf16 v[160:163], v[188:191], v[216:219], v[160:163]
    v_mfma_f32_16x16x32_bf16 v[180:183], v[192:195], v[216:219], v[180:183]
    v_mfma_f32_16x16x32_bf16 v[164:167], v[188:191], v[220:223], v[164:167]
    v_mfma_f32_16x16x32_bf16 v[184:187], v[192:195], v[220:223], v[184:187]
    s_waitcnt lgkmcnt(0)
    s_waitcnt vmcnt(13)
    s_barrier
    v_mfma_f32_16x16x32_bf16 v[148:151], v[196:199], v[224:227], v[148:151]
    ds_read_b64_tr_b16 v[188:189], v253 offset:0
    ds_read_b64_tr_b16 v[190:191], v253 offset:1024
    v_mfma_f32_16x16x32_bf16 v[168:171], v[200:203], v[224:227], v[168:171]
    ds_read_b128 v[204:207], v244 offset:40960
    ds_read_b64_tr_b16 v[192:193], v253 offset:8
    v_mfma_f32_16x16x32_bf16 v[152:155], v[196:199], v[228:231], v[152:155]
    ds_read_b64_tr_b16 v[194:195], v253 offset:1032
    ds_read_b128 v[208:211], v244 offset:45056
    v_mfma_f32_16x16x32_bf16 v[172:175], v[200:203], v[228:231], v[172:175]
    ds_read_b128 v[212:215], v248 offset:8192
    ds_read_b128 v[216:219], v248 offset:12288
    v_mfma_f32_16x16x32_bf16 v[156:159], v[196:199], v[232:235], v[156:159]
    ds_read_b128 v[220:223], v248 offset:40960
    s_add_u32 m0, s39, 147456
    s_nop 0
    buffer_load_dwordx4 v92, s[16:19], s92 offen lds
    v_mfma_f32_16x16x32_bf16 v[176:179], v[200:203], v[232:235], v[176:179]
    s_add_u32 m0, s39, 151552
    s_nop 0
    buffer_load_dwordx4 v93, s[16:19], s92 offen lds
    v_mfma_f32_16x16x32_bf16 v[160:163], v[196:199], v[236:239], v[160:163]
    s_add_u32 m0, s39, 155648
    s_nop 0
    buffer_load_dwordx4 v94, s[16:19], s92 offen lds
    v_mfma_f32_16x16x32_bf16 v[180:183], v[200:203], v[236:239], v[180:183]
    s_add_u32 m0, s39, 159744
    s_nop 0
    buffer_load_dwordx4 v95, s[16:19], s92 offen lds
    v_mfma_f32_16x16x32_bf16 v[164:167], v[196:199], v[240:243], v[164:167]
    v_mfma_f32_16x16x32_bf16 v[184:187], v[200:203], v[240:243], v[184:187]
    s_waitcnt lgkmcnt(0)
    v_mfma_f32_16x16x32_bf16 v[148:151], v[188:191], v[204:207], v[148:151]
    ds_read_b64_tr_b16 v[196:197], v253 offset:32768
    ds_read_b64_tr_b16 v[198:199], v253 offset:33792
    v_mfma_f32_16x16x32_bf16 v[168:171], v[192:195], v[204:207], v[168:171]
    ds_read_b128 v[224:227], v245 offset:40960
    ds_read_b64_tr_b16 v[200:201], v253 offset:32776
    v_mfma_f32_16x16x32_bf16 v[152:155], v[188:191], v[208:211], v[152:155]
    ds_read_b64_tr_b16 v[202:203], v253 offset:33800
    ds_read_b128 v[228:231], v245 offset:45056
    v_mfma_f32_16x16x32_bf16 v[172:175], v[192:195], v[208:211], v[172:175]
    ds_read_b128 v[232:235], v249 offset:8192
    ds_read_b128 v[236:239], v249 offset:12288
    v_mfma_f32_16x16x32_bf16 v[156:159], v[188:191], v[212:215], v[156:159]
    ds_read_b128 v[240:243], v249 offset:40960
    v_mfma_f32_16x16x32_bf16 v[176:179], v[192:195], v[212:215], v[176:179]
    v_mfma_f32_16x16x32_bf16 v[160:163], v[188:191], v[216:219], v[160:163]
    v_mfma_f32_16x16x32_bf16 v[180:183], v[192:195], v[216:219], v[180:183]
    v_mfma_f32_16x16x32_bf16 v[164:167], v[188:191], v[220:223], v[164:167]
    v_mfma_f32_16x16x32_bf16 v[184:187], v[192:195], v[220:223], v[184:187]
    s_waitcnt lgkmcnt(0)
    s_waitcnt vmcnt(13)
    s_barrier
    v_mfma_f32_16x16x32_bf16 v[148:151], v[196:199], v[224:227], v[148:151]
    ds_read_b64_tr_b16 v[188:189], v253 offset:24576
    ds_read_b64_tr_b16 v[190:191], v253 offset:25600
    v_mfma_f32_16x16x32_bf16 v[168:171], v[200:203], v[224:227], v[168:171]
    ds_read_b128 v[204:207], v246 offset:40960
    ds_read_b64_tr_b16 v[192:193], v253 offset:24584
    v_mfma_f32_16x16x32_bf16 v[152:155], v[196:199], v[228:231], v[152:155]
    ds_read_b64_tr_b16 v[194:195], v253 offset:25608
    ds_read_b128 v[208:211], v246 offset:45056
    v_mfma_f32_16x16x32_bf16 v[172:175], v[200:203], v[228:231], v[172:175]
    ds_read_b128 v[212:215], v250 offset:8192
    ds_read_b128 v[216:219], v250 offset:12288
    v_mfma_f32_16x16x32_bf16 v[156:159], v[196:199], v[232:235], v[156:159]
    ds_read_b128 v[220:223], v250 offset:40960
    s_and_b32 s60, s2, 15
    s_lshl_b32 s60, s60, 15
    s_or_b32 s36, s60, s34
    s_lshr_b64 s[2:3], s[2:3], 4
    s_cmp_ge_u32 s32, 16
    s_cselect_b32 s36, 0x80000, s36
    s_add_u32 s37, s36, 4096
    s_add_u32 s32, s32, 1
    s_add_u32 m0, s29, 0
    s_nop 0
    buffer_load_dwordx4 v22, s[8:11], s36 offen offset:0 lds
    buffer_load_dwordx4 v23, s[8:11], s36 offen offset:1024 lds
    v_mfma_f32_16x16x32_bf16 v[176:179], v[200:203], v[232:235], v[176:179]
    buffer_load_dwordx4 v24, s[8:11], s36 offen offset:2048 lds
    buffer_load_dwordx4 v25, s[8:11], s36 offen offset:3072 lds
    v_mfma_f32_16x16x32_bf16 v[160:163], v[196:199], v[236:239], v[160:163]
    s_add_u32 m0, s29, 4096
    s_nop 0
    buffer_load_dwordx4 v22, s[8:11], s37 offen offset:0 lds
    v_mfma_f32_16x16x32_bf16 v[180:183], v[200:203], v[236:239], v[180:183]
    buffer_load_dwordx4 v23, s[8:11], s37 offen offset:1024 lds
    v_mfma_f32_16x16x32_bf16 v[164:167], v[196:199], v[240:243], v[164:167]
    buffer_load_dwordx4 v24, s[8:11], s37 offen offset:2048 lds
    v_mfma_f32_16x16x32_bf16 v[184:187], v[200:203], v[240:243], v[184:187]
    buffer_load_dwordx4 v25, s[8:11], s37 offen offset:3072 lds
    s_waitcnt lgkmcnt(0)
    v_mfma_f32_16x16x32_bf16 v[148:151], v[188:191], v[204:207], v[148:151]
    ds_read_b64_tr_b16 v[196:197], v253 offset:57344
    ds_read_b64_tr_b16 v[198:199], v253 offset:58368
    v_mfma_f32_16x16x32_bf16 v[168:171], v[192:195], v[204:207], v[168:171]
    ds_read_b128 v[224:227], v247 offset:40960
    ds_read_b64_tr_b16 v[200:201], v253 offset:57352
    v_mfma_f32_16x16x32_bf16 v[152:155], v[188:191], v[208:211], v[152:155]
    ds_read_b64_tr_b16 v[202:203], v253 offset:58376
    ds_read_b128 v[228:231], v247 offset:45056
    v_mfma_f32_16x16x32_bf16 v[172:175], v[192:195], v[208:211], v[172:175]
    ds_read_b128 v[232:235], v251 offset:8192
    ds_read_b128 v[236:239], v251 offset:12288
    v_mfma_f32_16x16x32_bf16 v[156:159], v[188:191], v[212:215], v[156:159]
    ds_read_b128 v[240:243], v251 offset:40960
    v_mfma_f32_16x16x32_bf16 v[176:179], v[192:195], v[212:215], v[176:179]
    v_mfma_f32_16x16x32_bf16 v[160:163], v[188:191], v[216:219], v[160:163]
    v_mfma_f32_16x16x32_bf16 v[180:183], v[192:195], v[216:219], v[180:183]
    v_mfma_f32_16x16x32_bf16 v[164:167], v[188:191], v[220:223], v[164:167]
    v_mfma_f32_16x16x32_bf16 v[184:187], v[192:195], v[220:223], v[184:187]
    s_waitcnt lgkmcnt(0)
    s_waitcnt vmcnt(12)
    s_barrier
    v_mfma_f32_16x16x32_bf16 v[148:151], v[196:199], v[224:227], v[148:151]
    ds_read_b64_tr_b16 v[188:189], v254 offset:0
    ds_read_b64_tr_b16 v[190:191], v254 offset:1024
    v_mfma_f32_16x16x32_bf16 v[168:171], v[200:203], v[224:227], v[168:171]
    ds_read_b128 v[204:207], v248 offset:45056
    ds_read_b64_tr_b16 v[192:193], v254 offset:8
    v_mfma_f32_16x16x32_bf16 v[152:155], v[196:199], v[228:231], v[152:155]
    ds_read_b64_tr_b16 v[194:195], v254 offset:1032
    ds_read_b128 v[208:211], v244 offset:24576
    v_mfma_f32_16x16x32_bf16 v[172:175], v[200:203], v[228:231], v[172:175]
    ds_read_b128 v[212:215], v244 offset:28672
    ds_read_b128 v[216:219], v244 offset:57344
    v_mfma_f32_16x16x32_bf16 v[156:159], v[196:199], v[232:235], v[156:159]
    ds_read_b128 v[220:223], v244 offset:61440
    s_add_u32 m0, s29, 16384
    s_nop 0
    buffer_load_dwordx4 v26, s[12:15], s36 offen offset:0 lds
    buffer_load_dwordx4 v27, s[12:15], s36 offen offset:1024 lds
    v_mfma_f32_16x16x32_bf16 v[176:179], v[200:203], v[232:235], v[176:179]
    buffer_load_dwordx4 v26, s[12:15], s36 offen offset:2048 lds
    buffer_load_dwordx4 v27, s[12:15], s36 offen offset:3072 lds
    v_mfma_f32_16x16x32_bf16 v[160:163], v[196:199], v[236:239], v[160:163]
    s_add_u32 m0, s29, 20480
    s_nop 0
    buffer_load_dwordx4 v26, s[12:15], s37 offen offset:0 lds
    v_mfma_f32_16x16x32_bf16 v[180:183], v[200:203], v[236:239], v[180:183]
    buffer_load_dwordx4 v27, s[12:15], s37 offen offset:1024 lds
    v_mfma_f32_16x16x32_bf16 v[164:167], v[196:199], v[240:243], v[164:167]
    buffer_load_dwordx4 v26, s[12:15], s37 offen offset:2048 lds
    v_mfma_f32_16x16x32_bf16 v[184:187], v[200:203], v[240:243], v[184:187]
    buffer_load_dwordx4 v27, s[12:15], s37 offen offset:3072 lds
    s_waitcnt lgkmcnt(0)
    v_mfma_f32_16x16x32_bf16 v[148:151], v[188:191], v[204:207], v[148:151]
    ds_read_b64_tr_b16 v[196:197], v254 offset:8192
    ds_read_b64_tr_b16 v[198:199], v254 offset:9216
    v_mfma_f32_16x16x32_bf16 v[168:171], v[192:195], v[204:207], v[168:171]
    ds_read_b128 v[224:227], v249 offset:45056
    ds_read_b64_tr_b16 v[200:201], v254 offset:8200
    v_mfma_f32_16x16x32_bf16 v[152:155], v[188:191], v[208:211], v[152:155]
    ds_read_b64_tr_b16 v[202:203], v254 offset:9224
    ds_read_b128 v[228:231], v245 offset:24576
    v_mfma_f32_16x16x32_bf16 v[172:175], v[192:195], v[208:211], v[172:175]
    ds_read_b128 v[232:235], v245 offset:28672
    ds_read_b128 v[236:239], v245 offset:57344
    v_mfma_f32_16x16x32_bf16 v[156:159], v[188:191], v[212:215], v[156:159]
    ds_read_b128 v[240:243], v245 offset:61440
    v_mfma_f32_16x16x32_bf16 v[176:179], v[192:195], v[212:215], v[176:179]
    v_mfma_f32_16x16x32_bf16 v[160:163], v[188:191], v[216:219], v[160:163]
    v_mfma_f32_16x16x32_bf16 v[180:183], v[192:195], v[216:219], v[180:183]
    v_mfma_f32_16x16x32_bf16 v[164:167], v[188:191], v[220:223], v[164:167]
    v_mfma_f32_16x16x32_bf16 v[184:187], v[192:195], v[220:223], v[184:187]
    s_waitcnt lgkmcnt(0)
    s_waitcnt vmcnt(16)
    s_barrier
    s_cmp_eq_u32 s27, 0
    s_cbranch_scc0 L_noarr
    s_lshr_b32 s60, s81, 5
    v_mov_b32 v2, 1
    s_mov_b64 exec, 1
    buffer_atomic_add v2, off, s[56:59], s60 sc1
    s_mov_b64 exec, -1
    L_noarr:
    v_mfma_f32_16x16x32_bf16 v[148:151], v[196:199], v[224:227], v[148:151]
    ds_read_b64_tr_b16 v[188:189], v254 offset:16384
    ds_read_b64_tr_b16 v[190:191], v254 offset:17408
    v_mfma_f32_16x16x32_bf16 v[168:171], v[200:203], v[224:227], v[168:171]
    ds_read_b128 v[204:207], v250 offset:45056
    ds_read_b64_tr_b16 v[192:193], v254 offset:16392
    v_mfma_f32_16x16x32_bf16 v[152:155], v[196:199], v[228:231], v[152:155]
    ds_read_b64_tr_b16 v[194:195], v254 offset:17416
    ds_read_b128 v[208:211], v246 offset:24576
    v_mfma_f32_16x16x32_bf16 v[172:175], v[200:203], v[228:231], v[172:175]
    ds_read_b128 v[212:215], v246 offset:28672
    ds_read_b128 v[216:219], v246 offset:57344
    v_mfma_f32_16x16x32_bf16 v[156:159], v[196:199], v[232:235], v[156:159]
    ds_read_b128 v[220:223], v246 offset:61440
    v_mfma_f32_16x16x32_bf16 v[176:179], v[200:203], v[232:235], v[176:179]
    v_mfma_f32_16x16x32_bf16 v[160:163], v[196:199], v[236:239], v[160:163]
    v_mfma_f32_16x16x32_bf16 v[180:183], v[200:203], v[236:239], v[180:183]
    v_mfma_f32_16x16x32_bf16 v[164:167], v[196:199], v[240:243], v[164:167]
    v_mfma_f32_16x16x32_bf16 v[184:187], v[200:203], v[240:243], v[184:187]
    s_waitcnt lgkmcnt(0)
    v_mfma_f32_16x16x32_bf16 v[148:151], v[188:191], v[204:207], v[148:151]
    ds_read_b64_tr_b16 v[196:197], v254 offset:24576
    ds_read_b64_tr_b16 v[198:199], v254 offset:25600
    v_mfma_f32_16x16x32_bf16 v[168:171], v[192:195], v[204:207], v[168:171]
    ds_read_b128 v[224:227], v251 offset:45056
    ds_read_b64_tr_b16 v[200:201], v254 offset:24584
    v_mfma_f32_16x16x32_bf16 v[152:155], v[188:191], v[208:211], v[152:155]
    ds_read_b64_tr_b16 v[202:203], v254 offset:25608
    ds_read_b128 v[228:231], v247 offset:24576
    v_mfma_f32_16x16x32_bf16 v[172:175], v[192:195], v[208:211], v[172:175]
    ds_read_b128 v[232:235], v247 offset:28672
    ds_read_b128 v[236:239], v247 offset:57344
    v_mfma_f32_16x16x32_bf16 v[156:159], v[188:191], v[212:215], v[156:159]
    ds_read_b128 v[240:243], v247 offset:61440
    v_mfma_f32_16x16x32_bf16 v[176:179], v[192:195], v[212:215], v[176:179]
    v_mfma_f32_16x16x32_bf16 v[160:163], v[188:191], v[216:219], v[160:163]
    v_mfma_f32_16x16x32_bf16 v[180:183], v[192:195], v[216:219], v[180:183]
    v_mfma_f32_16x16x32_bf16 v[164:167], v[188:191], v[220:223], v[164:167]
    v_mfma_f32_16x16x32_bf16 v[184:187], v[192:195], v[220:223], v[184:187]
    s_waitcnt lgkmcnt(0)
    s_barrier
    v_mfma_f32_16x16x32_bf16 v[148:151], v[196:199], v[224:227], v[148:151]
    v_mfma_f32_16x16x32_bf16 v[168:171], v[200:203], v[224:227], v[168:171]
    v_mfma_f32_16x16x32_bf16 v[152:155], v[196:199], v[228:231], v[152:155]
    v_mfma_f32_16x16x32_bf16 v[172:175], v[200:203], v[228:231], v[172:175]
    s_and_b32 s60, s2, 15
    s_lshl_b32 s60, s60, 15
    s_or_b32 s36, s60, s34
    s_lshr_b64 s[2:3], s[2:3], 4
    s_cmp_ge_u32 s32, 16
    s_cselect_b32 s36, 0x80000, s36
    s_add_u32 s37, s36, 4096
    s_add_u32 s32, s32, 1
    s_add_u32 m0, s29, 8192
    s_nop 0
    buffer_load_dwordx4 v22, s[8:11], s36 offen offset:0 lds
    buffer_load_dwordx4 v23, s[8:11], s36 offen offset:1024 lds
    v_mfma_f32_16x16x32_bf16 v[156:159], v[196:199], v[232:235], v[156:159]
    buffer_load_dwordx4 v24, s[8:11], s36 offen offset:2048 lds
    v_mfma_f32_16x16x32_bf16 v[176:179], v[200:203], v[232:235], v[176:179]
    buffer_load_dwordx4 v25, s[8:11], s36 offen offset:3072 lds
    v_mfma_f32_16x16x32_bf16 v[160:163], v[196:199], v[236:239], v[160:163]
    s_add_u32 m0, s29, 12288
    s_nop 0
    buffer_load_dwordx4 v22, s[8:11], s37 offen offset:0 lds
    v_mfma_f32_16x16x32_bf16 v[180:183], v[200:203], v[236:239], v[180:183]
    buffer_load_dwordx4 v23, s[8:11], s37 offen offset:1024 lds
    v_mfma_f32_16x16x32_bf16 v[164:167], v[196:199], v[240:243], v[164:167]
    buffer_load_dwordx4 v24, s[8:11], s37 offen offset:2048 lds
    v_mfma_f32_16x16x32_bf16 v[184:187], v[200:203], v[240:243], v[184:187]
    buffer_load_dwordx4 v25, s[8:11], s37 offen offset:3072 lds
    s_mov_b32 s30, 0x3e0293ee
    v_add_u32 v8, s39, v38
    v_add_u32 v8, 131072, v8
    s_nop 4
    v_pk_mul_f32 v[148:149], v[148:149], s[30:31] op_sel_hi:[1,0]
    v_pk_mul_f32 v[150:151], v[150:151], s[30:31] op_sel_hi:[1,0]
    v_pk_mul_f32 v[168:169], v[168:169], s[30:31] op_sel_hi:[1,0]
    v_pk_mul_f32 v[170:171], v[170:171], s[30:31] op_sel_hi:[1,0]
    v_cvt_pk_bf16_f32 v204, v148, v149
    v_cvt_pk_bf16_f32 v205, v150, v151
    v_cvt_pk_bf16_f32 v206, v168, v169
    v_cvt_pk_bf16_f32 v207, v170, v171
    ds_write_b128 v8, v[204:207] offset:0
    v_pk_mul_f32 v[152:153], v[152:153], s[30:31] op_sel_hi:[1,0]
    v_pk_mul_f32 v[154:155], v[154:155], s[30:31] op_sel_hi:[1,0]
    v_pk_mul_f32 v[172:173], v[172:173], s[30:31] op_sel_hi:[1,0]
    v_pk_mul_f32 v[174:175], v[174:175], s[30:31] op_sel_hi:[1,0]
    v_cvt_pk_bf16_f32 v208, v152, v153
    v_cvt_pk_bf16_f32 v209, v154, v155
    v_cvt_pk_bf16_f32 v210, v172, v173
    v_cvt_pk_bf16_f32 v211, v174, v175
    ds_write_b128 v8, v[208:211] offset:4096
    v_pk_mul_f32 v[156:157], v[156:157], s[30:31] op_sel_hi:[1,0]
    v_pk_mul_f32 v[158:159], v[158:159], s[30:31] op_sel_hi:[1,0]
    v_pk_mul_f32 v[176:177], v[176:177], s[30:31] op_sel_hi:[1,0]
    v_pk_mul_f32 v[178:179], v[178:179], s[30:31] op_sel_hi:[1,0]
    v_cvt_pk_bf16_f32 v212, v156, v157
    v_cvt_pk_bf16_f32 v213, v158, v159
    v_cvt_pk_bf16_f32 v214, v176, v177
    v_cvt_pk_bf16_f32 v215, v178, v179
    ds_write_b128 v8, v[212:215] offset:8192
    v_pk_mul_f32 v[160:161], v[160:161], s[30:31] op_sel_hi:[1,0]
    v_pk_mul_f32 v[162:163], v[162:163], s[30:31] op_sel_hi:[1,0]
    v_pk_mul_f32 v[180:181], v[180:181], s[30:31] op_sel_hi:[1,0]
    v_pk_mul_f32 v[182:183], v[182:183], s[30:31] op_sel_hi:[1,0]
    v_cvt_pk_bf16_f32 v216, v160, v161
    v_cvt_pk_bf16_f32 v217, v162, v163
    v_cvt_pk_bf16_f32 v218, v180, v181
    v_cvt_pk_bf16_f32 v219, v182, v183
    ds_write_b128 v8, v[216:219] offset:12288
    v_pk_mul_f32 v[164:165], v[164:165], s[30:31] op_sel_hi:[1,0]
    v_pk_mul_f32 v[166:167], v[166:167], s[30:31] op_sel_hi:[1,0]
    v_pk_mul_f32 v[184:185], v[184:185], s[30:31] op_sel_hi:[1,0]
    v_pk_mul_f32 v[186:187], v[186:187], s[30:31] op_sel_hi:[1,0]
    v_cvt_pk_bf16_f32 v220, v164, v165
    v_cvt_pk_bf16_f32 v221, v166, v167
    v_cvt_pk_bf16_f32 v222, v184, v185
    v_cvt_pk_bf16_f32 v223, v186, v187
    ds_write_b128 v8, v[220:223] offset:16384
    s_branch L_qdone
L_qp2:
    ds_read_b64_tr_b16 v[188:189], v253 offset:24576
    ds_read_b64_tr_b16 v[190:191], v253 offset:25600
    ds_read_b128 v[204:207], v244 offset:16384
    ds_read_b64_tr_b16 v[192:193], v253 offset:24584
    ds_read_b64_tr_b16 v[194:195], v253 offset:25608
    ds_read_b128 v[208:211], v244 offset:20480
    ds_read_b128 v[212:215], v244 offset:49152
    ds_read_b128 v[216:219], v244 offset:53248
    ds_read_b128 v[220:223], v248 offset:16384
    s_waitcnt lgkmcnt(0)
    v_mfma_f32_16x16x32_bf16 v[148:151], v[188:191], v[204:207], 0
    ds_read_b64_tr_b16 v[196:197], v253 offset:57344
    ds_read_b64_tr_b16 v[198:199], v253 offset:58368
    v_mfma_f32_16x16x32_bf16 v[168:171], v[192:195], v[204:207], 0
    ds_read_b128 v[224:227], v245 offset:16384
    ds_read_b64_tr_b16 v[200:201], v253 offset:57352
    v_mfma_f32_16x16x32_bf16 v[152:155], v[188:191], v[208:211], 0
    ds_read_b64_tr_b16 v[202:203], v253 offset:58376
    ds_read_b128 v[228:231], v245 offset:20480
    v_mfma_f32_16x16x32_bf16 v[172:175], v[192:195], v[208:211], 0
    ds_read_b128 v[232:235], v245 offset:49152
    ds_read_b128 v[236:239], v245 offset:53248
    v_mfma_f32_16x16x32_bf16 v[156:159], v[188:191], v[212:215], 0
    ds_read_b128 v[240:243], v249 offset:16384
    s_add_u32 m0, s39, 86016
    s_nop 0
    buffer_load_dwordx4 v84, s[4:7], s89 offen lds
    s_add_u32 m0, s39, 114688
    s_nop 0
    buffer_load_dwordx4 v85, s[4:7], s89 offen lds
    v_mfma_f32_16x16x32_bf16 v[176:179], v[192:195], v[212:215], 0
    s_add_u32 m0, s39, 118784
    s_nop 0
    buffer_load_dwordx4 v86, s[4:7], s89 offen lds
    s_add_u32 m0, s39, 8192
    s_nop 0
    buffer_load_dwordx4 v87, s[4:7], s89 offen lds
    v_mfma_f32_16x16x32_bf16 v[160:163], v[188:191], v[216:219], 0
    s_add_u32 m0, s39, 12288
    s_nop 0
    buffer_load_dwordx4 v88, s[4:7], s89 offen lds
    s_add_u32 m0, s39, 147456
    s_nop 0
    buffer_load_dwordx4 v92, s[16:19], s97 offen lds
    v_mfma_f32_16x16x32_bf16 v[180:183], v[192:195], v[216:219], 0
    s_add_u32 m0, s39, 151552
    s_nop 0
    buffer_load_dwordx4 v93, s[16:19], s97 offen lds
    v_mfma_f32_16x16x32_bf16 v[164:167], v[188:191], v[220:223], 0
    s_add_u32 m0, s39, 155648
    s_nop 0
    buffer_load_dwordx4 v94, s[16:19], s97 offen lds
    v_mfma_f32_16x16x32_bf16 v[184:187], v[192:195], v[220:223], 0
    s_add_u32 m0, s39, 159744
    s_nop 0
    buffer_load_dwordx4 v95, s[16:19], s97 offen lds
    s_waitcnt lgkmcnt(0)
    s_waitcnt vmcnt(9)
    s_barrier
    v_mfma_f32_16x16x32_bf16 v[148:151], v[196:199], v[224:227], v[148:151]
    ds_read_b64_tr_b16 v[188:189], v254 offset:0
    ds_read_b64_tr_b16 v[190:191], v254 offset:1024
    v_mfma_f32_16x16x32_bf16 v[168:171], v[200:203], v[224:227], v[168:171]
    ds_read_b128 v[204:207], v246 offset:16384
    ds_read_b64_tr_b16 v[192:193], v254 offset:8
    v_mfma_f32_16x16x32_bf16 v[152:155], v[196:199], v[228:231], v[152:155]
    ds_read_b64_tr_b16 v[194:195], v254 offset:1032
    ds_read_b128 v[208:211], v246 offset:20480
    v_mfma_f32_16x16x32_bf16 v[172:175], v[200:203], v[228:231], v[172:175]
    ds_read_b128 v[212:215], v246 offset:49152
    ds_read_b128 v[216:219], v246 offset:53248
    v_mfma_f32_16x16x32_bf16 v[156:159], v[196:199], v[232:235], v[156:159]
    ds_read_b128 v[220:223], v250 offset:16384
    v_mfma_f32_16x16x32_bf16 v[176:179], v[200:203], v[232:235], v[176:179]
    v_mfma_f32_16x16x32_bf16 v[160:163], v[196:199], v[236:239], v[160:163]
    v_mfma_f32_16x16x32_bf16 v[180:183], v[200:203], v[236:239], v[180:183]
    v_mfma_f32_16x16x32_bf16 v[164:167], v[196:199], v[240:243], v[164:167]
    v_mfma_f32_16x16x32_bf16 v[184:187], v[200:203], v[240:243], v[184:187]
    s_waitcnt lgkmcnt(0)
    v_mfma_f32_16x16x32_bf16 v[148:151], v[188:191], v[204:207], v[148:151]
    ds_read_b64_tr_b16 v[196:197], v254 offset:8192
    ds_read_b64_tr_b16 v[198:199], v254 offset:9216
    v_mfma_f32_16x16x32_bf16 v[168:171], v[192:195], v[204:207], v[168:171]
    ds_read_b128 v[224:227], v247 offset:16384
    ds_read_b64_tr_b16 v[200:201], v254 offset:8200
    v_mfma_f32_16x16x32_bf16 v[152:155], v[188:191], v[208:211], v[152:155]
    ds_read_b64_tr_b16 v[202:203], v254 offset:9224
    ds_read_b128 v[228:231], v247 offset:20480
    v_mfma_f32_16x16x32_bf16 v[172:175], v[192:195], v[208:211], v[172:175]
    ds_read_b128 v[232:235], v247 offset:49152
    ds_read_b128 v[236:239], v247 offset:53248
    v_mfma_f32_16x16x32_bf16 v[156:159], v[188:191], v[212:215], v[156:159]
    ds_read_b128 v[240:243], v251 offset:16384
    s_add_u32 m0, s39, 0
    s_nop 0
    buffer_load_dwordx4 v92, s[16:19], s96 offen lds
    s_add_u32 m0, s39, 4096
    s_nop 0
    buffer_load_dwordx4 v93, s[16:19], s96 offen lds
    v_mfma_f32_16x16x32_bf16 v[176:179], v[192:195], v[212:215], v[176:179]
    s_add_u32 m0, s39, 32768
    s_nop 0
    buffer_load_dwordx4 v94, s[16:19], s96 offen lds
    s_add_u32 m0, s39, 36864
    s_nop 0
    buffer_load_dwordx4 v95, s[16:19], s96 offen lds
    v_mfma_f32_16x16x32_bf16 v[160:163], v[188:191], v[216:219], v[160:163]
    s_add_u32 m0, s39, 65536
    s_nop 0
    buffer_load_dwordx4 v92, s[16:19], s95 offen lds
    v_mfma_f32_16x16x32_bf16 v[180:183], v[192:195], v[216:219], v[180:183]
    s_add_u32 m0, s39, 69632
    s_nop 0
    buffer_load_dwordx4 v93, s[16:19], s95 offen lds
    v_mfma_f32_16x16x32_bf16 v[164:167], v[188:191], v[220:223], v[164:167]
    s_add_u32 m0, s39, 98304
    s_nop 0
    buffer_load_dwordx4 v94, s[16:19], s95 offen lds
    v_mfma_f32_16x16x32_bf16 v[184:187], v[192:195], v[220:223], v[184:187]
    s_add_u32 m0, s39, 102400
    s_nop 0
    buffer_load_dwordx4 v95, s[16:19], s95 offen lds
    s_waitcnt lgkmcnt(0)
    s_waitcnt vmcnt(8)
    s_barrier
    v_mfma_f32_16x16x32_bf16 v[148:151], v[196:199], v[224:227], v[148:151]
    ds_read_b64_tr_b16 v[188:189], v254 offset:16384
    ds_read_b64_tr_b16 v[190:191], v254 offset:17408
    v_mfma_f32_16x16x32_bf16 v[168:171], v[200:203], v[224:227], v[168:171]
    ds_read_b128 v[204:207], v248 offset:20480
    ds_read_b64_tr_b16 v[192:193], v254 offset:16392
    v_mfma_f32_16x16x32_bf16 v[152:155], v[196:199], v[228:231], v[152:155]
    ds_read_b64_tr_b16 v[194:195], v254 offset:17416
    ds_read_b128 v[208:211], v248 offset:49152
    v_mfma_f32_16x16x32_bf16 v[172:175], v[200:203], v[228:231], v[172:175]
    ds_read_b128 v[212:215], v248 offset:53248
    ds_read_b128 v[216:219], v244 offset:8192
    v_mfma_f32_16x16x32_bf16 v[156:159], v[196:199], v[232:235], v[156:159]
    ds_read_b128 v[220:223], v244 offset:12288
    v_mfma_f32_16x16x32_bf16 v[176:179], v[200:203], v[232:235], v[176:179]
    v_mfma_f32_16x16x32_bf16 v[160:163], v[196:199], v[236:239], v[160:163]
    v_mfma_f32_16x16x32_bf16 v[180:183], v[200:203], v[236:239], v[180:183]
    v_mfma_f32_16x16x32_bf16 v[164:167], v[196:199], v[240:243], v[164:167]
    v_mfma_f32_16x16x32_bf16 v[184:187], v[200:203], v[240:243], v[184:187]
    s_waitcnt lgkmcnt(0)
    v_mfma_f32_16x16x32_bf16 v[148:151], v[188:191], v[204:207], v[148:151]
    ds_read_b64_tr_b16 v[196:197], v254 offset:24576
    ds_read_b64_tr_b16 v[198:199], v254 offset:25600
    v_mfma_f32_16x16x32_bf16 v[168:171], v[192:195], v[204:207], v[168:171]
    ds_read_b128 v[224:227], v249 offset:20480
    ds_read_b64_tr_b16 v[200:201], v254 offset:24584
    v_mfma_f32_16x16x32_bf16 v[152:155], v[188:191], v[208:211], v[152:155]
    ds_read_b64_tr_b16 v[202:203], v254 offset:25608
    ds_read_b128 v[228:231], v249 offset:49152
    v_mfma_f32_16x16x32_bf16 v[172:175], v[192:195], v[208:211], v[172:175]
    ds_read_b128 v[232:235], v249 offset:53248
    ds_read_b128 v[236:239], v245 offset:8192
    v_mfma_f32_16x16x32_bf16 v[156:159], v[188:191], v[212:215], v[156:159]
    ds_read_b128 v[240:243], v245 offset:12288
    s_add_u32 m0, s39, 40960
    s_nop 0
    buffer_load_dwordx4 v84, s[4:7], s90 offen lds
    s_add_u32 m0, s39, 45056
    s_nop 0
    buffer_load_dwordx4 v85, s[4:7], s90 offen lds
    v_mfma_f32_16x16x32_bf16 v[176:179], v[192:195], v[212:215], v[176:179]
    s_add_u32 m0, s39, 73728
    s_nop 0
    buffer_load_dwordx4 v86, s[4:7], s90 offen lds
    s_add_u32 m0, s39, 77824
    s_nop 0
    buffer_load_dwordx4 v87, s[4:7], s90 offen lds
    v_mfma_f32_16x16x32_bf16 v[160:163], v[188:191], v[216:219], v[160:163]
    s_add_u32 m0, s39, 106496
    s_nop 0
    buffer_load_dwordx4 v88, s[4:7], s90 offen lds
    s_add_u32 m0, s39, 90112
    s_nop 0
    buffer_load_dwordx4 v92, s[16:19], s94 offen lds
    v_mfma_f32_16x16x32_bf16 v[180:183], v[192:195], v[216:219], v[180:183]
    s_add_u32 m0, s39, 94208
    s_nop 0
    buffer_load_dwordx4 v93, s[16:19], s94 offen lds
    v_mfma_f32_16x16x32_bf16 v[164:167], v[188:191], v[220:223], v[164:167]
    s_add_u32 m0, s39, 122880
    s_nop 0
    buffer_load_dwordx4 v94, s[16:19], s94 offen lds
    v_mfma_f32_16x16x32_bf16 v[184:187], v[192:195], v[220:223], v[184:187]
    s_add_u32 m0, s39, 126976
    s_nop 0
    buffer_load_dwordx4 v95, s[16:19], s94 offen lds
    s_waitcnt lgkmcnt(0)
    s_waitcnt vmcnt(13)
    s_barrier
    v_mfma_f32_16x16x32_bf16 v[148:151], v[196:199], v[224:227], v[148:151]
    ds_read_b64_tr_b16 v[188:189], v252 offset:0
    ds_read_b64_tr_b16 v[190:191], v252 offset:1024
    v_mfma_f32_16x16x32_bf16 v[168:171], v[200:203], v[224:227], v[168:171]
    ds_read_b128 v[204:207], v250 offset:20480
    ds_read_b64_tr_b16 v[192:193], v252 offset:8
    v_mfma_f32_16x16x32_bf16 v[152:155], v[196:199], v[228:231], v[152:155]
    ds_read_b64_tr_b16 v[194:195], v252 offset:1032
    ds_read_b128 v[208:211], v250 offset:49152
    v_mfma_f32_16x16x32_bf16 v[172:175], v[200:203], v[228:231], v[172:175]
    ds_read_b128 v[212:215], v250 offset:53248
    ds_read_b128 v[216:219], v246 offset:8192
    v_mfma_f32_16x16x32_bf16 v[156:159], v[196:199], v[232:235], v[156:159]
    ds_read_b128 v[220:223], v246 offset:12288
    v_mfma_f32_16x16x32_bf16 v[176:179], v[200:203], v[232:235], v[176:179]
    v_mfma_f32_16x16x32_bf16 v[160:163], v[196:199], v[236:239], v[160:163]
    v_mfma_f32_16x16x32_bf16 v[180:183], v[200:203], v[236:239], v[180:183]
    v_mfma_f32_16x16x32_bf16 v[164:167], v[196:199], v[240:243], v[164:167]
    v_mfma_f32_16x16x32_bf16 v[184:187], v[200:203], v[240:243], v[184:187]
    s_waitcnt lgkmcnt(0)
    v_mfma_f32_16x16x32_bf16 v[148:151], v[188:191], v[204:207], v[148:151]
    ds_read_b64_tr_b16 v[196:197], v252 offset:32768
    ds_read_b64_tr_b16 v[198:199], v252 offset:33792
    v_mfma_f32_16x16x32_bf16 v[168:171], v[192:195], v[204:207], v[168:171]
    ds_read_b128 v[224:227], v251 offset:20480
    ds_read_b64_tr_b16 v[200:201], v252 offset:32776
    v_mfma_f32_16x16x32_bf16 v[152:155], v[188:191], v[208:211], v[152:155]
    ds_read_b64_tr_b16 v[202:203], v252 offset:33800
    ds_read_b128 v[228:231], v251 offset:49152
    v_mfma_f32_16x16x32_bf16 v[172:175], v[192:195], v[208:211], v[172:175]
    ds_read_b128 v[232:235], v251 offset:53248
    ds_read_b128 v[236:239], v247 offset:8192
    v_mfma_f32_16x16x32_bf16 v[156:159], v[188:191], v[212:215], v[156:159]
    ds_read_b128 v[240:243], v247 offset:12288
    s_add_u32 m0, s39, 131072
    s_nop 0
    buffer_load_dwordx4 v92, s[16:19], s93 offen lds
    s_add_u32 m0, s39, 135168
    s_nop 0
    buffer_load_dwordx4 v93, s[16:19], s93 offen lds
    v_mfma_f32_16x16x32_bf16 v[176:179], v[192:195], v[212:215], v[176:179]
    s_add_u32 m0, s39, 139264
    s_nop 0
    buffer_load_dwordx4 v94, s[16:19], s93 offen lds
    s_add_u32 m0, s39, 143360
    s_nop 0
    buffer_load_dwordx4 v95, s[16:19], s93 offen lds
    v_mfma_f32_16x16x32_bf16 v[160:163], v[188:191], v[216:219], v[160:163]
    s_add_u32 m0, s39, 110592
    s_nop 0
    buffer_load_dwordx4 v84, s[4:7], s91 offen lds
    s_add_u32 m0, s39, 24576
    s_nop 0
    buffer_load_dwordx4 v85, s[4:7], s91 offen lds
    v_mfma_f32_16x16x32_bf16 v[180:183], v[192:195], v[216:219], v[180:183]
    s_add_u32 m0, s39, 28672
    s_nop 0
    buffer_load_dwordx4 v86, s[4:7], s91 offen lds
    v_mfma_f32_16x16x32_bf16 v[164:167], v[188:191], v[220:223], v[164:167]
    s_add_u32 m0, s39, 57344
    s_nop 0
    buffer_load_dwordx4 v87, s[4:7], s91 offen lds
    v_mfma_f32_16x16x32_bf16 v[184:187], v[192:195], v[220:223], v[184:187]
    s_add_u32 m0, s39, 61440
    s_nop 0
    buffer_load_dwordx4 v88, s[4:7], s91 offen lds
    s_waitcnt lgkmcnt(0)
    s_waitcnt vmcnt(13)
    s_barrier
    v_mfma_f32_16x16x32_bf16 v[148:151], v[196:199], v[224:227], v[148:151]
    ds_read_b64_tr_b16 v[188:189], v253 offset:0
    ds_read_b64_tr_b16 v[190:191], v253 offset:1024
    v_mfma_f32_16x16x32_bf16 v[168:171], v[200:203], v[224:227], v[168:171]
    ds_read_b128 v[204:207], v244 offset:40960
    ds_read_b64_tr_b16 v[192:193], v253 offset:8
    v_mfma_f32_16x16x32_bf16 v[152:155], v[196:199], v[228:231], v[152:155]
    ds_read_b64_tr_b16 v[194:195], v253 offset:1032
    ds_read_b128 v[208:211], v244 offset:45056
    v_mfma_f32_16x16x32_bf16 v[172:175], v[200:203], v[228:231], v[172:175]
    ds_read_b128 v[212:215], v248 offset:8192
    ds_read_b128 v[216:219], v248 offset:12288
    v_mfma_f32_16x16x32_bf16 v[156:159], v[196:199], v[232:235], v[156:159]
    ds_read_b128 v[220:223], v248 offset:40960
    v_mfma_f32_16x16x32_bf16 v[176:179], v[200:203], v[232:235], v[176:179]
    v_mfma_f32_16x16x32_bf16 v[160:163], v[196:199], v[236:239], v[160:163]
    v_mfma_f32_16x16x32_bf16 v[180:183], v[200:203], v[236:239], v[180:183]
    v_mfma_f32_16x16x32_bf16 v[164:167], v[196:199], v[240:243], v[164:167]
    v_mfma_f32_16x16x32_bf16 v[184:187], v[200:203], v[240:243], v[184:187]
    s_waitcnt lgkmcnt(0)
    v_mfma_f32_16x16x32_bf16 v[148:151], v[188:191], v[204:207], v[148:151]
    ds_read_b64_tr_b16 v[196:197], v253 offset:32768
    ds_read_b64_tr_b16 v[198:199], v253 offset:33792
    v_mfma_f32_16x16x32_bf16 v[168:171], v[192:195], v[204:207], v[168:171]
    ds_read_b128 v[224:227], v245 offset:40960
    ds_read_b64_tr_b16 v[200:201], v253 offset:32776
    v_mfma_f32_16x16x32_bf16 v[152:155], v[188:191], v[208:211], v[152:155]
    ds_read_b64_tr_b16 v[202:203], v253 offset:33800
    ds_read_b128 v[228:231], v245 offset:45056
    v_mfma_f32_16x16x32_bf16 v[172:175], v[192:195], v[208:211], v[172:175]
    ds_read_b128 v[232:235], v249 offset:8192
    ds_read_b128 v[236:239], v249 offset:12288
    v_mfma_f32_16x16x32_bf16 v[156:159], v[188:191], v[212:215], v[156:159]
    ds_read_b128 v[240:243], v249 offset:40960
    s_add_u32 m0, s39, 147456
    s_nop 0
    buffer_load_dwordx4 v92, s[16:19], s92 offen lds
    v_mfma_f32_16x16x32_bf16 v[176:179], v[192:195], v[212:215], v[176:179]
    s_add_u32 m0, s39, 151552
    s_nop 0
    buffer_load_dwordx4 v93, s[16:19], s92 offen lds
    v_mfma_f32_16x16x32_bf16 v[160:163], v[188:191], v[216:219], v[160:163]
    s_add_u32 m0, s39, 155648
    s_nop 0
    buffer_load_dwordx4 v94, s[16:19], s92 offen lds
    v_mfma_f32_16x16x32_bf16 v[180:183], v[192:195], v[216:219], v[180:183]
    s_add_u32 m0, s39, 159744
    s_nop 0
    buffer_load_dwordx4 v95, s[16:19], s92 offen lds
    v_mfma_f32_16x16x32_bf16 v[164:167], v[188:191], v[220:223], v[164:167]
    v_mfma_f32_16x16x32_bf16 v[184:187], v[192:195], v[220:223], v[184:187]
    s_waitcnt lgkmcnt(0)
    s_waitcnt vmcnt(13)
    s_barrier
    v_mfma_f32_16x16x32_bf16 v[148:151], v[196:199], v[224:227], v[148:151]
    ds_read_b64_tr_b16 v[188:189], v253 offset:24576
    ds_read_b64_tr_b16 v[190:191], v253 offset:25600
    v_mfma_f32_16x16x32_bf16 v[168:171], v[200:203], v[224:227], v[168:171]
    ds_read_b128 v[204:207], v246 offset:40960
    ds_read_b64_tr_b16 v[192:193], v253 offset:24584
    v_mfma_f32_16x16x32_bf16 v[152:155], v[196:199], v[228:231], v[152:155]
    ds_read_b64_tr_b16 v[194:195], v253 offset:25608
    ds_read_b128 v[208:211], v246 offset:45056
    v_mfma_f32_16x16x32_bf16 v[172:175], v[200:203], v[228:231], v[172:175]
    ds_read_b128 v[212:215], v250 offset:8192
    ds_read_b128 v[216:219], v250 offset:12288
    v_mfma_f32_16x16x32_bf16 v[156:159], v[196:199], v[232:235], v[156:159]
    ds_read_b128 v[220:223], v250 offset:40960
    v_mfma_f32_16x16x32_bf16 v[176:179], v[200:203], v[232:235], v[176:179]
    v_mfma_f32_16x16x32_bf16 v[160:163], v[196:199], v[236:239], v[160:163]
    v_mfma_f32_16x16x32_bf16 v[180:183], v[200:203], v[236:239], v[180:183]
    v_mfma_f32_16x16x32_bf16 v[164:167], v[196:199], v[240:243], v[164:167]
    v_mfma_f32_16x16x32_bf16 v[184:187], v[200:203], v[240:243], v[184:187]
    s_waitcnt lgkmcnt(0)
    v_mfma_f32_16x16x32_bf16 v[148:151], v[188:191], v[204:207], v[148:151]
    ds_read_b64_tr_b16 v[196:197], v253 offset:57344
    ds_read_b64_tr_b16 v[198:199], v253 offset:58368
    v_mfma_f32_16x16x32_bf16 v[168:171], v[192:195], v[204:207], v[168:171]
    ds_read_b128 v[224:227], v247 offset:40960
    ds_read_b64_tr_b16 v[200:201], v253 offset:57352
    v_mfma_f32_16x16x32_bf16 v[152:155], v[188:191], v[208:211], v[152:155]
    ds_read_b64_tr_b16 v[202:203], v253 offset:58376
    ds_read_b128 v[228:231], v247 offset:45056
    v_mfma_f32_16x16x32_bf16 v[172:175], v[192:195], v[208:211], v[172:175]
    ds_read_b128 v[232:235], v251 offset:8192
    ds_read_b128 v[236:239], v251 offset:12288
    v_mfma_f32_16x16x32_bf16 v[156:159], v[188:191], v[212:215], v[156:159]
    ds_read_b128 v[240:243], v251 offset:40960
    s_and_b32 s60, s2, 15
    s_lshl_b32 s60, s60, 15
    s_or_b32 s36, s60, s34
    s_lshr_b64 s[2:3], s[2:3], 4
    s_cmp_ge_u32 s32, 16
    s_cselect_b32 s36, 0x80000, s36
    s_add_u32 s37, s36, 4096
    s_add_u32 s32, s32, 1
    s_add_u32 m0, s29, 0
    s_nop 0
    buffer_load_dwordx4 v22, s[8:11], s36 offen offset:0 lds
    buffer_load_dwordx4 v23, s[8:11], s36 offen offset:1024 lds
    v_mfma_f32_16x16x32_bf16 v[176:179], v[192:195], v[212:215], v[176:179]
    buffer_load_dwordx4 v24, s[8:11], s36 offen offset:2048 lds
    buffer_load_dwordx4 v25, s[8:11], s36 offen offset:3072 lds
    v_mfma_f32_16x16x32_bf16 v[160:163], v[188:191], v[216:219], v[160:163]
    s_add_u32 m0, s29, 4096
    s_nop 0
    buffer_load_dwordx4 v22, s[8:11], s37 offen offset:0 lds
    v_mfma_f32_16x16x32_bf16 v[180:183], v[192:195], v[216:219], v[180:183]
    buffer_load_dwordx4 v23, s[8:11], s37 offen offset:1024 lds
    v_mfma_f32_16x16x32_bf16 v[164:167], v[188:191], v[220:223], v[164:167]
    buffer_load_dwordx4 v24, s[8:11], s37 offen offset:2048 lds
    v_mfma_f32_16x16x32_bf16 v[184:187], v[192:195], v[220:223], v[184:187]
    buffer_load_dwordx4 v25, s[8:11], s37 offen offset:3072 lds
    s_waitcnt lgkmcnt(0)
    s_waitcnt vmcnt(12)
    s_barrier
    v_mfma_f32_16x16x32_bf16 v[148:151], v[196:199], v[224:227], v[148:151]
    ds_read_b64_tr_b16 v[188:189], v254 offset:0
    ds_read_b64_tr_b16 v[190:191], v254 offset:1024
    v_mfma_f32_16x16x32_bf16 v[168:171], v[200:203], v[224:227], v[168:171]
    ds_read_b128 v[204:207], v248 offset:45056
    ds_read_b64_tr_b16 v[192:193], v254 offset:8
    v_mfma_f32_16x16x32_bf16 v[152:155], v[196:199], v[228:231], v[152:155]
    ds_read_b64_tr_b16 v[194:195], v254 offset:1032
    ds_read_b128 v[208:211], v244 offset:24576
    v_mfma_f32_16x16x32_bf16 v[172:175], v[200:203], v[228:231], v[172:175]
    ds_read_b128 v[212:215], v244 offset:28672
    ds_read_b128 v[216:219], v244 offset:57344
    v_mfma_f32_16x16x32_bf16 v[156:159], v[196:199], v[232:235], v[156:159]
    ds_read_b128 v[220:223], v244 offset:61440
    v_mfma_f32_16x16x32_bf16 v[176:179], v[200:203], v[232:235], v[176:179]
    v_mfma_f32_16x16x32_bf16 v[160:163], v[196:199], v[236:239], v[160:163]
    v_mfma_f32_16x16x32_bf16 v[180:183], v[200:203], v[236:239], v[180:183]
    v_mfma_f32_16x16x32_bf16 v[164:167], v[196:199], v[240:243], v[164:167]
    v_mfma_f32_16x16x32_bf16 v[184:187], v[200:203], v[240:243], v[184:187]
    s_waitcnt lgkmcnt(0)
    v_mfma_f32_16x16x32_bf16 v[148:151], v[188:191], v[204:207], v[148:151]
    ds_read_b64_tr_b16 v[196:197], v254 offset:8192
    ds_read_b64_tr_b16 v[198:199], v254 offset:9216
    v_mfma_f32_16x16x32_bf16 v[168:171], v[192:195], v[204:207], v[168:171]
    ds_read_b128 v[224:227], v249 offset:45056
    ds_read_b64_tr_b16 v[200:201], v254 offset:8200
    v_mfma_f32_16x16x32_bf16 v[152:155], v[188:191], v[208:211], v[152:155]
    ds_read_b64_tr_b16 v[202:203], v254 offset:9224
    ds_read_b128 v[228:231], v245 offset:24576
    v_mfma_f32_16x16x32_bf16 v[172:175], v[192:195], v[208:211], v[172:175]
    ds_read_b128 v[232:235], v245 offset:28672
    ds_read_b128 v[236:239], v245 offset:57344
    v_mfma_f32_16x16x32_bf16 v[156:159], v[188:191], v[212:215], v[156:159]
    ds_read_b128 v[240:243], v245 offset:61440
    s_add_u32 m0, s29, 16384
    s_nop 0
    buffer_load_dwordx4 v26, s[12:15], s36 offen offset:0 lds
    buffer_load_dwordx4 v27, s[12:15], s36 offen offset:1024 lds
    v_mfma_f32_16x16x32_bf16 v[176:179], v[192:195], v[212:215], v[176:179]
    buffer_load_dwordx4 v26, s[12:15], s36 offen offset:2048 lds
    buffer_load_dwordx4 v27, s[12:15], s36 offen offset:3072 lds
    v_mfma_f32_16x16x32_bf16 v[160:163], v[188:191], v[216:219], v[160:163]
    s_add_u32 m0, s29, 20480
    s_nop 0
    buffer_load_dwordx4 v26, s[12:15], s37 offen offset:0 lds
    v_mfma_f32_16x16x32_bf16 v[180:183], v[192:195], v[216:219], v[180:183]
    buffer_load_dwordx4 v27, s[12:15], s37 offen offset:1024 lds
    v_mfma_f32_16x16x32_bf16 v[164:167], v[188:191], v[220:223], v[164:167]
    buffer_load_dwordx4 v26, s[12:15], s37 offen offset:2048 lds
    v_mfma_f32_16x16x32_bf16 v[184:187], v[192:195], v[220:223], v[184:187]
    buffer_load_dwordx4 v27, s[12:15], s37 offen offset:3072 lds
    s_waitcnt lgkmcnt(0)
    s_waitcnt vmcnt(16)
    s_barrier
    v_mfma_f32_16x16x32_bf16 v[148:151], v[196:199], v[224:227], v[148:151]
    ds_read_b64_tr_b16 v[188:189], v254 offset:16384
    ds_read_b64_tr_b16 v[190:191], v254 offset:17408
    v_mfma_f32_16x16x32_bf16 v[168:171], v[200:203], v[224:227], v[168:171]
    ds_read_b128 v[204:207], v250 offset:45056
    ds_read_b64_tr_b16 v[192:193], v254 offset:16392
    v_mfma_f32_16x16x32_bf16 v[152:155], v[196:199], v[228:231], v[152:155]
    ds_read_b64_tr_b16 v[194:195], v254 offset:17416
    ds_read_b128 v[208:211], v246 offset:24576
    v_mfma_f32_16x16x32_bf16 v[172:175], v[200:203], v[228:231], v[172:175]
    ds_read_b128 v[212:215], v246 offset:28672
    ds_read_b128 v[216:219], v246 offset:57344
    v_mfma_f32_16x16x32_bf16 v[156:159], v[196:199], v[232:235], v[156:159]
    ds_read_b128 v[220:223], v246 offset:61440
    v_mfma_f32_16x16x32_bf16 v[176:179], v[200:203], v[232:235], v[176:179]
    v_mfma_f32_16x16x32_bf16 v[160:163], v[196:199], v[236:239], v[160:163]
    v_mfma_f32_16x16x32_bf16 v[180:183], v[200:203], v[236:239], v[180:183]
    v_mfma_f32_16x16x32_bf16 v[164:167], v[196:199], v[240:243], v[164:167]
    v_mfma_f32_16x16x32_bf16 v[184:187], v[200:203], v[240:243], v[184:187]
    s_waitcnt lgkmcnt(0)
    v_mfma_f32_16x16x32_bf16 v[148:151], v[188:191], v[204:207], v[148:151]
    ds_read_b64_tr_b16 v[196:197], v254 offset:24576
    ds_read_b64_tr_b16 v[198:199], v254 offset:25600
    v_mfma_f32_16x16x32_bf16 v[168:171], v[192:195], v[204:207], v[168:171]
    ds_read_b128 v[224:227], v251 offset:45056
    ds_read_b64_tr_b16 v[200:201], v254 offset:24584
    v_mfma_f32_16x16x32_bf16 v[152:155], v[188:191], v[208:211], v[152:155]
    ds_read_b64_tr_b16 v[202:203], v254 offset:25608
    ds_read_b128 v[228:231], v247 offset:24576
    v_mfma_f32_16x16x32_bf16 v[172:175], v[192:195], v[208:211], v[172:175]
    ds_read_b128 v[232:235], v247 offset:28672
    ds_read_b128 v[236:239], v247 offset:57344
    v_mfma_f32_16x16x32_bf16 v[156:159], v[188:191], v[212:215], v[156:159]
    ds_read_b128 v[240:243], v247 offset:61440
    v_mfma_f32_16x16x32_bf16 v[176:179], v[192:195], v[212:215], v[176:179]
    v_mfma_f32_16x16x32_bf16 v[160:163], v[188:191], v[216:219], v[160:163]
    v_mfma_f32_16x16x32_bf16 v[180:183], v[192:195], v[216:219], v[180:183]
    v_mfma_f32_16x16x32_bf16 v[164:167], v[188:191], v[220:223], v[164:167]
    v_mfma_f32_16x16x32_bf16 v[184:187], v[192:195], v[220:223], v[184:187]
    s_waitcnt lgkmcnt(0)
    s_barrier
    v_mfma_f32_16x16x32_bf16 v[148:151], v[196:199], v[224:227], v[148:151]
    v_mfma_f32_16x16x32_bf16 v[168:171], v[200:203], v[224:227], v[168:171]
    v_mfma_f32_16x16x32_bf16 v[152:155], v[196:199], v[228:231], v[152:155]
    v_mfma_f32_16x16x32_bf16 v[172:175], v[200:203], v[228:231], v[172:175]
    v_mfma_f32_16x16x32_bf16 v[156:159], v[196:199], v[232:235], v[156:159]
    v_mfma_f32_16x16x32_bf16 v[176:179], v[200:203], v[232:235], v[176:179]
    v_mfma_f32_16x16x32_bf16 v[160:163], v[196:199], v[236:239], v[160:163]
    v_mfma_f32_16x16x32_bf16 v[180:183], v[200:203], v[236:239], v[180:183]
    v_mfma_f32_16x16x32_bf16 v[164:167], v[196:199], v[240:243], v[164:167]
    v_mfma_f32_16x16x32_bf16 v[184:187], v[200:203], v[240:243], v[184:187]
    s_mov_b32 s30, 0x3e0293ee
    v_add_u32 v8, s39, v38
    v_add_u32 v8, 131072, v8
    s_nop 4
    v_pk_mul_f32 v[148:149], v[148:149], s[30:31] op_sel_hi:[1,0]
    v_pk_mul_f32 v[150:151], v[150:151], s[30:31] op_sel_hi:[1,0]
    v_pk_mul_f32 v[168:169], v[168:169], s[30:31] op_sel_hi:[1,0]
    v_pk_mul_f32 v[170:171], v[170:171], s[30:31] op_sel_hi:[1,0]
    v_cvt_pk_bf16_f32 v204, v148, v149
    v_cvt_pk_bf16_f32 v205, v150, v151
    v_cvt_pk_bf16_f32 v206, v168, v169
    v_cvt_pk_bf16_f32 v207, v170, v171
    ds_write_b128 v8, v[204:207] offset:0
    v_pk_mul_f32 v[152:153], v[152:153], s[30:31] op_sel_hi:[1,0]
    v_pk_mul_f32 v[154:155], v[154:155], s[30:31] op_sel_hi:[1,0]
    v_pk_mul_f32 v[172:173], v[172:173], s[30:31] op_sel_hi:[1,0]
    v_pk_mul_f32 v[174:175], v[174:175], s[30:31] op_sel_hi:[1,0]
    v_cvt_pk_bf16_f32 v208, v152, v153
    v_cvt_pk_bf16_f32 v209, v154, v155
    v_cvt_pk_bf16_f32 v210, v172, v173
    v_cvt_pk_bf16_f32 v211, v174, v175
    ds_write_b128 v8, v[208:211] offset:4096
    s_and_b32 s60, s2, 15
    s_lshl_b32 s60, s60, 15
    s_or_b32 s36, s60, s34
    s_lshr_b64 s[2:3], s[2:3], 4
    s_cmp_ge_u32 s32, 16
    s_cselect_b32 s36, 0x80000, s36
    s_add_u32 s37, s36, 4096
    s_add_u32 s32, s32, 1
    s_add_u32 m0, s29, 8192
    s_nop 0
    buffer_load_dwordx4 v22, s[8:11], s36 offen offset:0 lds
    buffer_load_dwordx4 v23, s[8:11], s36 offen offset:1024 lds
    buffer_load_dwordx4 v24, s[8:11], s36 offen offset:2048 lds
    buffer_load_dwordx4 v25, s[8:11], s36 offen offset:3072 lds
    s_add_u32 m0, s29, 12288
    s_nop 0
    buffer_load_dwordx4 v22, s[8:11], s37 offen offset:0 lds
    buffer_load_dwordx4 v23, s[8:11], s37 offen offset:1024 lds
    buffer_load_dwordx4 v24, s[8:11], s37 offen offset:2048 lds
    buffer_load_dwordx4 v25, s[8:11], s37 offen offset:3072 lds
    v_pk_mul_f32 v[156:157], v[156:157], s[30:31] op_sel_hi:[1,0]
    v_pk_mul_f32 v[158:159], v[158:159], s[30:31] op_sel_hi:[1,0]
    v_pk_mul_f32 v[176:177], v[176:177], s[30:31] op_sel_hi:[1,0]
    v_pk_mul_f32 v[178:179], v[178:179], s[30:31] op_sel_hi:[1,0]
    v_cvt_pk_bf16_f32 v212, v156, v157
    v_cvt_pk_bf16_f32 v213, v158, v159
    v_cvt_pk_bf16_f32 v214, v176, v177
    v_cvt_pk_bf16_f32 v215, v178, v179
    ds_write_b128 v8, v[212:215] offset:8192
    v_pk_mul_f32 v[160:161], v[160:161], s[30:31] op_sel_hi:[1,0]
    v_pk_mul_f32 v[162:163], v[162:163], s[30:31] op_sel_hi:[1,0]
    v_pk_mul_f32 v[180:181], v[180:181], s[30:31] op_sel_hi:[1,0]
    v_pk_mul_f32 v[182:183], v[182:183], s[30:31] op_sel_hi:[1,0]
    v_cvt_pk_bf16_f32 v216, v160, v161
    v_cvt_pk_bf16_f32 v217, v162, v163
    v_cvt_pk_bf16_f32 v218, v180, v181
    v_cvt_pk_bf16_f32 v219, v182, v183
    ds_write_b128 v8, v[216:219] offset:12288
    v_pk_mul_f32 v[164:165], v[164:165], s[30:31] op_sel_hi:[1,0]
    v_pk_mul_f32 v[166:167], v[166:167], s[30:31] op_sel_hi:[1,0]
    v_pk_mul_f32 v[184:185], v[184:185], s[30:31] op_sel_hi:[1,0]
    v_pk_mul_f32 v[186:187], v[186:187], s[30:31] op_sel_hi:[1,0]
    v_cvt_pk_bf16_f32 v220, v164, v165
    v_cvt_pk_bf16_f32 v221, v166, v167
    v_cvt_pk_bf16_f32 v222, v184, v185
    v_cvt_pk_bf16_f32 v223, v186, v187
    ds_write_b128 v8, v[220:223] offset:16384
L_qdone:
    s_waitcnt vmcnt(16) lgkmcnt(0)
    s_barrier
    v_add_u32 v8, 131072, v38
    ds_read_b128 v[188:191], v244 offset:0
    ds_read_b128 v[192:195], v245 offset:0
    ds_read_b128 v[196:199], v246 offset:0
    ds_read_b128 v[200:203], v247 offset:0
    ds_read_b128 a[160:163], v8 offset:0
    ds_read_b128 a[164:167], v8 offset:1024
    ds_read_b128 a[168:171], v8 offset:2048
    ds_read_b128 a[172:175], v8 offset:3072
    ds_read_b128 a[176:179], v8 offset:4096
    ds_read_b128 a[180:183], v8 offset:5120
    ds_read_b128 a[184:187], v8 offset:6144
    ds_read_b128 a[188:191], v8 offset:7168
    ds_read_b128 a[192:195], v8 offset:8192
    ds_read_b128 a[196:199], v8 offset:9216
    ds_read_b128 a[200:203], v8 offset:10240
    ds_read_b128 a[204:207], v8 offset:11264
    ds_read_b128 a[208:211], v8 offset:12288
    ds_read_b128 a[212:215], v8 offset:13312
    ds_read_b128 a[216:219], v8 offset:14336
    ds_read_b128 a[220:223], v8 offset:15360
    ds_read_b128 a[224:227], v8 offset:16384
    ds_read_b128 a[228:231], v8 offset:17408
    ds_read_b128 a[232:235], v8 offset:18432
    ds_read_b128 a[236:239], v8 offset:19456
    v_lshl_add_u32 v8, v4, 2, v5
    s_lshl_b32 s30, s27, 2
    v_add_u32 v9, s30, v6
    v_lshlrev_b32 v2, 2, v5
    v_xor_b32 v9, v9, v2
    v_lshlrev_b32 v9, 4, v9
    v_lshl_add_u32 v9, v8, 8, v9
    v_add_u32 v8, s30, v4
    v_lshlrev_b32 v2, 2, v4
    v_xor_b32 v2, v3, v2
    v_lshlrev_b32 v2, 4, v2
    v_mov_b32 v148, 0
    v_mov_b32 v149, 0
    v_mov_b32 v150, 0
    v_mov_b32 v151, 0
    v_mov_b32 v152, 0
    v_mov_b32 v153, 0
    v_mov_b32 v154, 0
    v_mov_b32 v155, 0
    v_mov_b32 v156, 0
    v_mov_b32 v157, 0
    v_mov_b32 v158, 0
    v_mov_b32 v159, 0
    v_mov_b32 v160, 0
    v_mov_b32 v161, 0
    v_mov_b32 v162, 0
    v_mov_b32 v163, 0
    v_mov_b32 v164, 0
    v_mov_b32 v165, 0
    v_mov_b32 v166, 0
    v_mov_b32 v167, 0
    v_mov_b32 v168, 0x3f803f80
    v_mov_b32 v169, 0x3f803f80
    v_mov_b32 v170, 0x3f803f80
    v_mov_b32 v171, 0x3f803f80
    s_waitcnt lgkmcnt(15)
    v_mfma_f32_16x16x32_bf16 v[40:43], v[188:191], a[160:163], 0
    ds_read_b128 v[84:87], v10 offset:0
    v_mfma_f32_16x16x32_bf16 v[40:43], v[192:195], a[164:167], v[40:43]
    ds_read_b128 v[88:91], v11 offset:0
    v_mfma_f32_16x16x32_bf16 v[40:43], v[196:199], a[168:171], v[40:43]
    ds_read_b128 v[92:95], v12 offset:0
    v_mfma_f32_16x16x32_bf16 v[40:43], v[200:203], a[172:175], v[40:43]
    ds_read_b128 v[96:99], v13 offset:0
    s_waitcnt lgkmcnt(15)
    v_mfma_f32_16x16x32_bf16 v[44:47], v[188:191], a[176:179], 0
    ds_read_b128 v[100:103], v10 offset:4096
    v_mfma_f32_16x16x32_bf16 v[44:47], v[192:195], a[180:183], v[44:47]
    ds_read_b128 v[104:107], v11 offset:4096
    v_mfma_f32_16x16x32_bf16 v[44:47], v[196:199], a[184:187], v[44:47]
    ds_read_b128 v[108:111], v12 offset:4096
    v_mfma_f32_16x16x32_bf16 v[44:47], v[200:203], a[188:191], v[44:47]
    ds_read_b128 v[112:115], v13 offset:4096
    s_waitcnt lgkmcnt(15)
    v_mfma_f32_16x16x32_bf16 v[48:51], v[188:191], a[192:195], 0
    s_add_u32 m0, s29, 24576
    s_nop 0
    buffer_load_dwordx4 v26, s[12:15], s36 offen offset:0 lds
    v_mfma_f32_16x16x32_bf16 v[48:51], v[192:195], a[196:199], v[48:51]
    buffer_load_dwordx4 v27, s[12:15], s36 offen offset:1024 lds
    v_mfma_f32_16x16x32_bf16 v[48:51], v[196:199], a[200:203], v[48:51]
    buffer_load_dwordx4 v26, s[12:15], s36 offen offset:2048 lds
    v_mfma_f32_16x16x32_bf16 v[48:51], v[200:203], a[204:207], v[48:51]
    buffer_load_dwordx4 v27, s[12:15], s36 offen offset:3072 lds
    s_waitcnt lgkmcnt(12)
    v_mfma_f32_16x16x32_bf16 v[52:55], v[188:191], a[208:211], 0
    s_add_u32 m0, s29, 28672
    s_nop 0
    buffer_load_dwordx4 v26, s[12:15], s37 offen offset:0 lds
    v_mfma_f32_16x16x32_bf16 v[52:55], v[192:195], a[212:215], v[52:55]
    buffer_load_dwordx4 v27, s[12:15], s37 offen offset:1024 lds
    v_mfma_f32_16x16x32_bf16 v[52:55], v[196:199], a[216:219], v[52:55]
    buffer_load_dwordx4 v26, s[12:15], s37 offen offset:2048 lds
    v_mfma_f32_16x16x32_bf16 v[52:55], v[200:203], a[220:223], v[52:55]
    buffer_load_dwordx4 v27, s[12:15], s37 offen offset:3072 lds
    s_waitcnt lgkmcnt(8)
    v_mfma_f32_16x16x32_bf16 v[56:59], v[188:191], a[224:227], 0
    v_mfma_f32_16x16x32_bf16 v[56:59], v[192:195], a[228:231], v[56:59]
    v_mfma_f32_16x16x32_bf16 v[56:59], v[196:199], a[232:235], v[56:59]
    v_mfma_f32_16x16x32_bf16 v[56:59], v[200:203], a[236:239], v[56:59]
    v_add_u32 v245, 0x10000, v9
    v_add_u32 v246, 0x20000, v9
    v_lshl_add_u32 v247, v8, 10, v2
    v_add_u32 v244, 0x10000, v38
    s_nop 4
    v_max3_f32 v204, v40, v41, v42
    v_max3_f32 v205, v44, v45, v46
    v_max3_f32 v206, v48, v49, v50
    v_max3_f32 v207, v52, v53, v54
    v_max3_f32 v208, v56, v57, v58
    v_max_f32 v204, v204, v43
    v_max_f32 v205, v205, v47
    v_max_f32 v206, v206, v51
    v_max_f32 v207, v207, v55
    v_max_f32 v208, v208, v59
    v_mov_b32 v212, v204
    v_mov_b32 v213, v205
    v_mov_b32 v214, v206
    v_mov_b32 v215, v207
    v_mov_b32 v216, v208
    v_permlane32_swap_b32 v204, v212
    v_permlane32_swap_b32 v205, v213
    v_permlane32_swap_b32 v206, v214
    v_permlane32_swap_b32 v207, v215
    v_permlane32_swap_b32 v208, v216
    v_max_f32 v204, v204, v212
    v_max_f32 v205, v205, v213
    v_max_f32 v206, v206, v214
    v_max_f32 v207, v207, v215
    v_max_f32 v208, v208, v216
    v_mov_b32 v212, v204
    v_mov_b32 v213, v205
    v_mov_b32 v214, v206
    v_mov_b32 v215, v207
    v_mov_b32 v216, v208
    v_permlane16_swap_b32 v204, v212
    v_permlane16_swap_b32 v205, v213
    v_permlane16_swap_b32 v206, v214
    v_permlane16_swap_b32 v207, v215
    v_permlane16_swap_b32 v208, v216
    v_max_f32 v204, v204, v212
    v_max_f32 v205, v205, v213
    v_max_f32 v206, v206, v214
    v_max_f32 v207, v207, v215
    v_max_f32 v208, v208, v216
    v_xor_b32 v40, 0x80000000, v204
    v_xor_b32 v41, 0x80000000, v204
    v_xor_b32 v42, 0x80000000, v204
    v_xor_b32 v43, 0x80000000, v204
    v_xor_b32 v44, 0x80000000, v205
    v_xor_b32 v45, 0x80000000, v205
    v_xor_b32 v46, 0x80000000, v205
    v_xor_b32 v47, 0x80000000, v205
    v_xor_b32 v48, 0x80000000, v206
    v_xor_b32 v49, 0x80000000, v206
    v_xor_b32 v50, 0x80000000, v206
    v_xor_b32 v51, 0x80000000, v206
    v_xor_b32 v52, 0x80000000, v207
    v_xor_b32 v53, 0x80000000, v207
    v_xor_b32 v54, 0x80000000, v207
    v_xor_b32 v55, 0x80000000, v207
    v_xor_b32 v56, 0x80000000, v208
    v_xor_b32 v57, 0x80000000, v208
    v_xor_b32 v58, 0x80000000, v208
    v_xor_b32 v59, 0x80000000, v208
    s_waitcnt lgkmcnt(0)
    s_barrier
    s_mov_b32 s38, 7
    v_mfma_f32_16x16x32_bf16 v[60:63], v[84:87], a[160:163], v[40:43]
    s_and_b32 s60, s2, 15
    s_lshl_b32 s60, s60, 15
    v_mfma_f32_16x16x32_bf16 v[60:63], v[88:91], a[164:167], v[60:63]
    s_or_b32 s36, s60, s34
    s_lshr_b64 s[2:3], s[2:3], 4
    v_mfma_f32_16x16x32_bf16 v[60:63], v[92:95], a[168:171], v[60:63]
    s_cmp_ge_u32 s32, 16
    s_cselect_b32 s36, 0x80000, s36
    v_mfma_f32_16x16x32_bf16 v[60:63], v[96:99], a[172:175], v[60:63]
    s_add_u32 s37, s36, 4096
    s_add_u32 s32, s32, 1
    v_mfma_f32_16x16x32_bf16 v[64:67], v[100:103], a[160:163], v[40:43]
    v_mfma_f32_16x16x32_bf16 v[64:67], v[104:107], a[164:167], v[64:67]
    s_waitcnt lgkmcnt(0)
    v_mfma_f32_16x16x32_bf16 v[64:67], v[108:111], a[168:171], v[64:67]
    s_add_u32 m0, s29, 0
    v_mfma_f32_16x16x32_bf16 v[64:67], v[112:115], a[172:175], v[64:67]
    buffer_load_dwordx4 v22, s[8:11], s36 offen offset:0 lds
    buffer_load_dwordx4 v23, s[8:11], s36 offen offset:1024 lds
    buffer_load_dwordx4 v24, s[8:11], s36 offen offset:2048 lds
    v_mfma_f32_16x16x32_bf16 v[68:71], v[84:87], a[176:179], v[44:47]
    v_exp_f32 v60, v60
    v_mfma_f32_16x16x32_bf16 v[68:71], v[88:91], a[180:183], v[68:71]
    v_exp_f32 v61, v61
    v_mfma_f32_16x16x32_bf16 v[68:71], v[92:95], a[184:187], v[68:71]
    v_cvt_pk_bf16_f32 v76, v60, v61
    v_mfma_f32_16x16x32_bf16 v[68:71], v[96:99], a[188:191], v[68:71]
    buffer_load_dwordx4 v25, s[8:11], s36 offen offset:3072 lds
    v_mfma_f32_16x16x32_bf16 v[72:75], v[100:103], a[176:179], v[44:47]
    s_add_u32 m0, s29, 4096
    v_exp_f32 v62, v62
    v_mfma_f32_16x16x32_bf16 v[72:75], v[104:107], a[180:183], v[72:75]
    v_exp_f32 v63, v63
    v_mfma_f32_16x16x32_bf16 v[72:75], v[108:111], a[184:187], v[72:75]
    v_cvt_pk_bf16_f32 v77, v62, v63
    v_mfma_f32_16x16x32_bf16 v[72:75], v[112:115], a[188:191], v[72:75]
    buffer_load_dwordx4 v22, s[8:11], s37 offen offset:0 lds
    v_exp_f32 v64, v64
    s_waitcnt vmcnt(21)
    v_exp_f32 v65, v65
    s_nop 0
    ds_read_b64_tr_b16 v[116:117], v14 offset:16384
    v_cvt_pk_bf16_f32 v78, v64, v65
    ds_read_b64_tr_b16 v[118:119], v14 offset:20480
    ds_read_b64_tr_b16 v[120:121], v15 offset:16384
    buffer_load_dwordx4 v23, s[8:11], s37 offen offset:1024 lds
    v_exp_f32 v66, v66
    v_exp_f32 v67, v67
    s_nop 0
    ds_read_b64_tr_b16 v[122:123], v15 offset:20480
    v_cvt_pk_bf16_f32 v79, v66, v67
    ds_read_b64_tr_b16 v[124:125], v16 offset:16384
    ds_read_b64_tr_b16 v[126:127], v16 offset:20480
    ds_read_b64_tr_b16 v[128:129], v17 offset:16384
    ds_read_b64_tr_b16 v[130:131], v17 offset:20480
    s_branch L_loop2
.p2align 6
L_loop:
    v_mfma_f32_16x16x32_bf16 v[60:63], v[84:87], a[160:163], v[40:43]
    s_and_b32 s60, s2, 15
    s_lshl_b32 s60, s60, 15
    v_exp_f32 v68, v68
    v_mfma_f32_16x16x32_bf16 v[60:63], v[88:91], a[164:167], v[60:63]
    s_or_b32 s36, s60, s34
    s_lshr_b64 s[2:3], s[2:3], 4
    v_exp_f32 v69, v69
    v_mfma_f32_16x16x32_bf16 v[60:63], v[92:95], a[168:171], v[60:63]
    s_cmp_ge_u32 s32, 16
    s_cselect_b32 s36, 0x80000, s36
    v_cvt_pk_bf16_f32 v80, v68, v69
    v_mfma_f32_16x16x32_bf16 v[60:63], v[96:99], a[172:175], v[60:63]
    s_add_u32 s37, s36, 4096
    s_add_u32 s32, s32, 1
    v_mfma_f32_16x16x32_bf16 v[64:67], v[100:103], a[160:163], v[40:43]
    v_exp_f32 v70, v70
    v_mfma_f32_16x16x32_bf16 v[64:67], v[104:107], a[164:167], v[64:67]
    s_waitcnt lgkmcnt(0)
    v_exp_f32 v71, v71
    v_mfma_f32_16x16x32_bf16 v[64:67], v[108:111], a[168:171], v[64:67]
    s_add_u32 m0, s29, 0
    v_cvt_pk_bf16_f32 v81, v70, v71
    v_mfma_f32_16x16x32_bf16 v[64:67], v[112:115], a[172:175], v[64:67]
    buffer_load_dwordx4 v22, s[8:11], s36 offen offset:0 lds
    v_mfma_f32_16x16x32_bf16 a[96:99], v[116:119], v[76:79], a[96:99]
    v_exp_f32 v72, v72
    v_mfma_f32_16x16x32_bf16 a[100:103], v[120:123], v[76:79], a[100:103]
    v_exp_f32 v73, v73
    v_mfma_f32_16x16x32_bf16 a[104:107], v[124:127], v[76:79], a[104:107]
    v_cvt_pk_bf16_f32 v82, v72, v73
    v_mfma_f32_16x16x32_bf16 a[108:111], v[128:131], v[76:79], a[108:111]
    buffer_load_dwordx4 v23, s[8:11], s36 offen offset:1024 lds
    v_mfma_f32_16x16x32_bf16 a[112:115], v[132:135], v[76:79], a[112:115]
    v_exp_f32 v74, v74
    v_mfma_f32_16x16x32_bf16 a[116:119], v[136:139], v[76:79], a[116:119]
    v_exp_f32 v75, v75
    v_mfma_f32_16x16x32_bf16 a[120:123], v[140:143], v[76:79], a[120:123]
    v_cvt_pk_bf16_f32 v83, v74, v75
    v_mfma_f32_16x16x32_bf16 a[124:127], v[144:147], v[76:79], a[124:127]
    buffer_load_dwordx4 v24, s[8:11], s36 offen offset:2048 lds
    v_mfma_f32_16x16x32_bf16 v[160:163], v[168:171], v[76:79], v[160:163]
    s_cmp_eq_u32 s38, 1
    s_cbranch_scc1 L_side
L_side_back:
    v_mfma_f32_16x16x32_bf16 v[68:71], v[84:87], a[176:179], v[44:47]
    v_exp_f32 v60, v60
    v_mfma_f32_16x16x32_bf16 v[68:71], v[88:91], a[180:183], v[68:71]
    v_exp_f32 v61, v61
    v_mfma_f32_16x16x32_bf16 v[68:71], v[92:95], a[184:187], v[68:71]
    v_cvt_pk_bf16_f32 v76, v60, v61
    v_mfma_f32_16x16x32_bf16 v[68:71], v[96:99], a[188:191], v[68:71]
    buffer_load_dwordx4 v25, s[8:11], s36 offen offset:3072 lds
    v_mfma_f32_16x16x32_bf16 v[72:75], v[100:103], a[176:179], v[44:47]
    s_add_u32 m0, s29, 4096
    v_exp_f32 v62, v62
    v_mfma_f32_16x16x32_bf16 v[72:75], v[104:107], a[180:183], v[72:75]
    v_exp_f32 v63, v63
    v_mfma_f32_16x16x32_bf16 v[72:75], v[108:111], a[184:187], v[72:75]
    v_cvt_pk_bf16_f32 v77, v62, v63
    v_mfma_f32_16x16x32_bf16 v[72:75], v[112:115], a[188:191], v[72:75]
    buffer_load_dwordx4 v22, s[8:11], s37 offen offset:0 lds
    v_mfma_f32_16x16x32_bf16 a[128:131], v[116:119], v[80:83], a[128:131]
    v_exp_f32 v64, v64
    v_mfma_f32_16x16x32_bf16 a[132:135], v[120:123], v[80:83], a[132:135]
    s_waitcnt vmcnt(21)
    v_exp_f32 v65, v65
    v_mfma_f32_16x16x32_bf16 a[136:139], v[124:127], v[80:83], a[136:139]
    ds_read_b64_tr_b16 v[116:117], v14 offset:16384
    v_cvt_pk_bf16_f32 v78, v64, v65
    v_mfma_f32_16x16x32_bf16 a[140:143], v[128:131], v[80:83], a[140:143]
    ds_read_b64_tr_b16 v[118:119], v14 offset:20480
    ds_read_b64_tr_b16 v[120:121], v15 offset:16384
    v_mfma_f32_16x16x32_bf16 a[144:147], v[132:135], v[80:83], a[144:147]
    buffer_load_dwordx4 v23, s[8:11], s37 offen offset:1024 lds
    v_exp_f32 v66, v66
    v_mfma_f32_16x16x32_bf16 a[148:151], v[136:139], v[80:83], a[148:151]
    v_exp_f32 v67, v67
    v_mfma_f32_16x16x32_bf16 a[152:155], v[140:143], v[80:83], a[152:155]
    ds_read_b64_tr_b16 v[122:123], v15 offset:20480
    v_cvt_pk_bf16_f32 v79, v66, v67
    v_mfma_f32_16x16x32_bf16 a[156:159], v[144:147], v[80:83], a[156:159]
    ds_read_b64_tr_b16 v[124:125], v16 offset:16384
    ds_read_b64_tr_b16 v[126:127], v16 offset:20480
    v_mfma_f32_16x16x32_bf16 v[164:167], v[168:171], v[80:83], v[164:167]
    ds_read_b64_tr_b16 v[128:129], v17 offset:16384
    ds_read_b64_tr_b16 v[130:131], v17 offset:20480
L_loop2:
    v_mfma_f32_16x16x32_bf16 v[60:63], v[84:87], a[192:195], v[48:51]
    v_exp_f32 v68, v68
    v_mfma_f32_16x16x32_bf16 v[60:63], v[88:91], a[196:199], v[60:63]
    v_exp_f32 v69, v69
    v_mfma_f32_16x16x32_bf16 v[60:63], v[92:95], a[200:203], v[60:63]
    ds_read_b64_tr_b16 v[132:133], v18 offset:16384
    ds_read_b64_tr_b16 v[134:135], v18 offset:20480
    v_cvt_pk_bf16_f32 v80, v68, v69
    v_mfma_f32_16x16x32_bf16 v[60:63], v[96:99], a[204:207], v[60:63]
    ds_read_b64_tr_b16 v[136:137], v19 offset:16384
    ds_read_b64_tr_b16 v[138:139], v19 offset:20480
    v_mfma_f32_16x16x32_bf16 v[64:67], v[100:103], a[192:195], v[48:51]
    v_exp_f32 v70, v70
    v_mfma_f32_16x16x32_bf16 v[64:67], v[104:107], a[196:199], v[64:67]
    v_exp_f32 v71, v71
    v_mfma_f32_16x16x32_bf16 v[64:67], v[108:111], a[200:203], v[64:67]
    ds_read_b64_tr_b16 v[140:141], v20 offset:16384
    ds_read_b64_tr_b16 v[142:143], v20 offset:20480
    v_cvt_pk_bf16_f32 v81, v70, v71
    v_mfma_f32_16x16x32_bf16 v[64:67], v[112:115], a[204:207], v[64:67]
    ds_read_b64_tr_b16 v[144:145], v21 offset:16384
    ds_read_b64_tr_b16 v[146:147], v21 offset:20480
    s_waitcnt lgkmcnt(8)
    v_mfma_f32_16x16x32_bf16 a[0:3], v[116:119], v[76:79], a[0:3]
    v_exp_f32 v72, v72
    v_mfma_f32_16x16x32_bf16 a[4:7], v[120:123], v[76:79], a[4:7]
    v_exp_f32 v73, v73
    v_mfma_f32_16x16x32_bf16 a[8:11], v[124:127], v[76:79], a[8:11]
    v_cvt_pk_bf16_f32 v82, v72, v73
    v_mfma_f32_16x16x32_bf16 a[12:15], v[128:131], v[76:79], a[12:15]
    buffer_load_dwordx4 v24, s[8:11], s37 offen offset:2048 lds
    s_waitcnt lgkmcnt(2)
    v_mfma_f32_16x16x32_bf16 a[16:19], v[132:135], v[76:79], a[16:19]
    v_exp_f32 v74, v74
    v_mfma_f32_16x16x32_bf16 a[20:23], v[136:139], v[76:79], a[20:23]
    v_exp_f32 v75, v75
    v_mfma_f32_16x16x32_bf16 a[24:27], v[140:143], v[76:79], a[24:27]
    s_waitcnt lgkmcnt(0)
    v_cvt_pk_bf16_f32 v83, v74, v75
    v_mfma_f32_16x16x32_bf16 a[28:31], v[144:147], v[76:79], a[28:31]
    v_mfma_f32_16x16x32_bf16 v[148:151], v[168:171], v[76:79], v[148:151]
    buffer_load_dwordx4 v25, s[8:11], s37 offen offset:3072 lds
    v_mfma_f32_16x16x32_bf16 v[68:71], v[84:87], a[208:211], v[52:55]
    s_add_u32 m0, s29, 16384
    v_exp_f32 v60, v60
    v_mfma_f32_16x16x32_bf16 v[68:71], v[88:91], a[212:215], v[68:71]
    v_exp_f32 v61, v61
    v_mfma_f32_16x16x32_bf16 v[68:71], v[92:95], a[216:219], v[68:71]
    v_cvt_pk_bf16_f32 v76, v60, v61
    v_mfma_f32_16x16x32_bf16 v[68:71], v[96:99], a[220:223], v[68:71]
    buffer_load_dwordx4 v26, s[12:15], s36 offen offset:0 lds
    v_mfma_f32_16x16x32_bf16 v[72:75], v[100:103], a[208:211], v[52:55]
    v_exp_f32 v62, v62
    v_mfma_f32_16x16x32_bf16 v[72:75], v[104:107], a[212:215], v[72:75]
    v_exp_f32 v63, v63
    v_mfma_f32_16x16x32_bf16 v[72:75], v[108:111], a[216:219], v[72:75]
    v_cvt_pk_bf16_f32 v77, v62, v63
    v_mfma_f32_16x16x32_bf16 v[72:75], v[112:115], a[220:223], v[72:75]
    buffer_load_dwordx4 v27, s[12:15], s36 offen offset:1024 lds
    v_mfma_f32_16x16x32_bf16 a[32:35], v[116:119], v[80:83], a[32:35]
    v_exp_f32 v64, v64
    v_mfma_f32_16x16x32_bf16 a[36:39], v[120:123], v[80:83], a[36:39]
    v_exp_f32 v65, v65
    v_mfma_f32_16x16x32_bf16 a[40:43], v[124:127], v[80:83], a[40:43]
    v_cvt_pk_bf16_f32 v78, v64, v65
    v_mfma_f32_16x16x32_bf16 a[44:47], v[128:131], v[80:83], a[44:47]
    buffer_load_dwordx4 v26, s[12:15], s36 offen offset:2048 lds
    v_mfma_f32_16x16x32_bf16 a[48:51], v[132:135], v[80:83], a[48:51]
    v_exp_f32 v66, v66
    v_mfma_f32_16x16x32_bf16 a[52:55], v[136:139], v[80:83], a[52:55]
    v_exp_f32 v67, v67
    v_mfma_f32_16x16x32_bf16 a[56:59], v[140:143], v[80:83], a[56:59]
    v_cvt_pk_bf16_f32 v79, v66, v67
    v_mfma_f32_16x16x32_bf16 a[60:63], v[144:147], v[80:83], a[60:63]
    buffer_load_dwordx4 v27, s[12:15], s36 offen offset:3072 lds
    v_mfma_f32_16x16x32_bf16 v[152:155], v[168:171], v[80:83], v[152:155]
    s_waitcnt vmcnt(20)
    v_mfma_f32_16x16x32_bf16 v[60:63], v[84:87], a[224:227], v[56:59]
    s_add_u32 m0, s29, 20480
    v_exp_f32 v68, v68
    v_mfma_f32_16x16x32_bf16 v[60:63], v[88:91], a[228:231], v[60:63]
    v_exp_f32 v69, v69
    v_mfma_f32_16x16x32_bf16 v[60:63], v[92:95], a[232:235], v[60:63]
    ds_read_b128 v[84:87], v10 offset:8192
    v_cvt_pk_bf16_f32 v80, v68, v69
    v_mfma_f32_16x16x32_bf16 v[60:63], v[96:99], a[236:239], v[60:63]
    ds_read_b128 v[88:91], v11 offset:8192
    ds_read_b128 v[92:95], v12 offset:8192
    v_mfma_f32_16x16x32_bf16 v[64:67], v[100:103], a[224:227], v[56:59]
    buffer_load_dwordx4 v26, s[12:15], s37 offen offset:0 lds
    v_exp_f32 v70, v70
    v_mfma_f32_16x16x32_bf16 v[64:67], v[104:107], a[228:231], v[64:67]
    v_exp_f32 v71, v71
    v_mfma_f32_16x16x32_bf16 v[64:67], v[108:111], a[232:235], v[64:67]
    ds_read_b128 v[96:99], v13 offset:8192
    v_cvt_pk_bf16_f32 v81, v70, v71
    v_mfma_f32_16x16x32_bf16 v[64:67], v[112:115], a[236:239], v[64:67]
    ds_read_b128 v[100:103], v10 offset:12288
    ds_read_b128 v[104:107], v11 offset:12288
    v_mfma_f32_16x16x32_bf16 a[64:67], v[116:119], v[76:79], a[64:67]
    buffer_load_dwordx4 v27, s[12:15], s37 offen offset:1024 lds
    v_exp_f32 v72, v72
    v_mfma_f32_16x16x32_bf16 a[68:71], v[120:123], v[76:79], a[68:71]
    v_exp_f32 v73, v73
    v_mfma_f32_16x16x32_bf16 a[72:75], v[124:127], v[76:79], a[72:75]
    ds_read_b128 v[108:111], v12 offset:12288
    v_cvt_pk_bf16_f32 v82, v72, v73
    v_mfma_f32_16x16x32_bf16 a[76:79], v[128:131], v[76:79], a[76:79]
    ds_read_b128 v[112:115], v13 offset:12288
    v_mfma_f32_16x16x32_bf16 a[80:83], v[132:135], v[76:79], a[80:83]
    buffer_load_dwordx4 v26, s[12:15], s37 offen offset:2048 lds
    v_exp_f32 v74, v74
    v_mfma_f32_16x16x32_bf16 a[84:87], v[136:139], v[76:79], a[84:87]
    v_exp_f32 v75, v75
    v_mfma_f32_16x16x32_bf16 a[88:91], v[140:143], v[76:79], a[88:91]
    v_cvt_pk_bf16_f32 v83, v74, v75
    v_mfma_f32_16x16x32_bf16 a[92:95], v[144:147], v[76:79], a[92:95]
    buffer_load_dwordx4 v27, s[12:15], s37 offen offset:3072 lds
    v_mfma_f32_16x16x32_bf16 v[156:159], v[168:171], v[76:79], v[156:159]
    s_waitcnt lgkmcnt(2)
    v_mfma_f32_16x16x32_bf16 v[68:71], v[84:87], a[160:163], v[40:43]
    s_and_b32 s60, s2, 15
    s_lshl_b32 s60, s60, 15
    v_exp_f32 v60, v60
    v_mfma_f32_16x16x32_bf16 v[68:71], v[88:91], a[164:167], v[68:71]
    s_or_b32 s36, s60, s34
    s_lshr_b64 s[2:3], s[2:3], 4
    v_exp_f32 v61, v61
    v_mfma_f32_16x16x32_bf16 v[68:71], v[92:95], a[168:171], v[68:71]
    s_cmp_ge_u32 s32, 16
    s_cselect_b32 s36, 0x80000, s36
    v_cvt_pk_bf16_f32 v76, v60, v61
    v_mfma_f32_16x16x32_bf16 v[68:71], v[96:99], a[172:175], v[68:71]
    s_add_u32 s37, s36, 4096
    s_add_u32 s32, s32, 1
    v_mfma_f32_16x16x32_bf16 v[72:75], v[100:103], a[160:163], v[40:43]
    v_exp_f32 v62, v62
    v_mfma_f32_16x16x32_bf16 v[72:75], v[104:107], a[164:167], v[72:75]
    s_waitcnt lgkmcnt(0)
    v_exp_f32 v63, v63
    v_mfma_f32_16x16x32_bf16 v[72:75], v[108:111], a[168:171], v[72:75]
    s_add_u32 m0, s29, 8192
    v_cvt_pk_bf16_f32 v77, v62, v63
    v_mfma_f32_16x16x32_bf16 v[72:75], v[112:115], a[172:175], v[72:75]
    buffer_load_dwordx4 v22, s[8:11], s36 offen offset:0 lds
    v_mfma_f32_16x16x32_bf16 a[96:99], v[116:119], v[80:83], a[96:99]
    v_exp_f32 v64, v64
    v_mfma_f32_16x16x32_bf16 a[100:103], v[120:123], v[80:83], a[100:103]
    v_exp_f32 v65, v65
    v_mfma_f32_16x16x32_bf16 a[104:107], v[124:127], v[80:83], a[104:107]
    v_cvt_pk_bf16_f32 v78, v64, v65
    v_mfma_f32_16x16x32_bf16 a[108:111], v[128:131], v[80:83], a[108:111]
    buffer_load_dwordx4 v23, s[8:11], s36 offen offset:1024 lds
    v_mfma_f32_16x16x32_bf16 a[112:115], v[132:135], v[80:83], a[112:115]
    v_exp_f32 v66, v66
    v_mfma_f32_16x16x32_bf16 a[116:119], v[136:139], v[80:83], a[116:119]
    v_exp_f32 v67, v67
    v_mfma_f32_16x16x32_bf16 a[120:123], v[140:143], v[80:83], a[120:123]
    v_cvt_pk_bf16_f32 v79, v66, v67
    v_mfma_f32_16x16x32_bf16 a[124:127], v[144:147], v[80:83], a[124:127]
    buffer_load_dwordx4 v24, s[8:11], s36 offen offset:2048 lds
    v_mfma_f32_16x16x32_bf16 v[160:163], v[168:171], v[80:83], v[160:163]
    v_mfma_f32_16x16x32_bf16 v[60:63], v[84:87], a[176:179], v[44:47]
    v_exp_f32 v68, v68
    v_mfma_f32_16x16x32_bf16 v[60:63], v[88:91], a[180:183], v[60:63]
    v_exp_f32 v69, v69
    v_mfma_f32_16x16x32_bf16 v[60:63], v[92:95], a[184:187], v[60:63]
    v_cvt_pk_bf16_f32 v80, v68, v69
    v_mfma_f32_16x16x32_bf16 v[60:63], v[96:99], a[188:191], v[60:63]
    buffer_load_dwordx4 v25, s[8:11], s36 offen offset:3072 lds
    v_mfma_f32_16x16x32_bf16 v[64:67], v[100:103], a[176:179], v[44:47]
    s_add_u32 m0, s29, 12288
    v_exp_f32 v70, v70
    v_mfma_f32_16x16x32_bf16 v[64:67], v[104:107], a[180:183], v[64:67]
    v_exp_f32 v71, v71
    v_mfma_f32_16x16x32_bf16 v[64:67], v[108:111], a[184:187], v[64:67]
    v_cvt_pk_bf16_f32 v81, v70, v71
    v_mfma_f32_16x16x32_bf16 v[64:67], v[112:115], a[188:191], v[64:67]
    buffer_load_dwordx4 v22, s[8:11], s37 offen offset:0 lds
    v_mfma_f32_16x16x32_bf16 a[128:131], v[116:119], v[76:79], a[128:131]
    v_exp_f32 v72, v72
    v_mfma_f32_16x16x32_bf16 a[132:135], v[120:123], v[76:79], a[132:135]
    s_waitcnt vmcnt(21)
    v_exp_f32 v73, v73
    v_mfma_f32_16x16x32_bf16 a[136:139], v[124:127], v[76:79], a[136:139]
    ds_read_b64_tr_b16 v[116:117], v14 offset:24576
    v_cvt_pk_bf16_f32 v82, v72, v73
    v_mfma_f32_16x16x32_bf16 a[140:143], v[128:131], v[76:79], a[140:143]
    ds_read_b64_tr_b16 v[118:119], v14 offset:28672
    ds_read_b64_tr_b16 v[120:121], v15 offset:24576
    v_mfma_f32_16x16x32_bf16 a[144:147], v[132:135], v[76:79], a[144:147]
    buffer_load_dwordx4 v23, s[8:11], s37 offen offset:1024 lds
    v_exp_f32 v74, v74
    v_mfma_f32_16x16x32_bf16 a[148:151], v[136:139], v[76:79], a[148:151]
    v_exp_f32 v75, v75
    v_mfma_f32_16x16x32_bf16 a[152:155], v[140:143], v[76:79], a[152:155]
    ds_read_b64_tr_b16 v[122:123], v15 offset:28672
    v_cvt_pk_bf16_f32 v83, v74, v75
    v_mfma_f32_16x16x32_bf16 a[156:159], v[144:147], v[76:79], a[156:159]
    ds_read_b64_tr_b16 v[124:125], v16 offset:24576
    ds_read_b64_tr_b16 v[126:127], v16 offset:28672
    v_mfma_f32_16x16x32_bf16 v[164:167], v[168:171], v[76:79], v[164:167]
    ds_read_b64_tr_b16 v[128:129], v17 offset:24576
    ds_read_b64_tr_b16 v[130:131], v17 offset:28672
    v_mfma_f32_16x16x32_bf16 v[68:71], v[84:87], a[192:195], v[48:51]
    v_exp_f32 v60, v60
    v_mfma_f32_16x16x32_bf16 v[68:71], v[88:91], a[196:199], v[68:71]
    v_exp_f32 v61, v61
    v_mfma_f32_16x16x32_bf16 v[68:71], v[92:95], a[200:203], v[68:71]
    ds_read_b64_tr_b16 v[132:133], v18 offset:24576
    ds_read_b64_tr_b16 v[134:135], v18 offset:28672
    v_cvt_pk_bf16_f32 v76, v60, v61
    v_mfma_f32_16x16x32_bf16 v[68:71], v[96:99], a[204:207], v[68:71]
    ds_read_b64_tr_b16 v[136:137], v19 offset:24576
    ds_read_b64_tr_b16 v[138:139], v19 offset:28672
    v_mfma_f32_16x16x32_bf16 v[72:75], v[100:103], a[192:195], v[48:51]
    v_exp_f32 v62, v62
    v_mfma_f32_16x16x32_bf16 v[72:75], v[104:107], a[196:199], v[72:75]
    v_exp_f32 v63, v63
    v_mfma_f32_16x16x32_bf16 v[72:75], v[108:111], a[200:203], v[72:75]
    ds_read_b64_tr_b16 v[140:141], v20 offset:24576
    ds_read_b64_tr_b16 v[142:143], v20 offset:28672
    v_cvt_pk_bf16_f32 v77, v62, v63
    v_mfma_f32_16x16x32_bf16 v[72:75], v[112:115], a[204:207], v[72:75]
    ds_read_b64_tr_b16 v[144:145], v21 offset:24576
    ds_read_b64_tr_b16 v[146:147], v21 offset:28672
    s_waitcnt lgkmcnt(8)
    v_mfma_f32_16x16x32_bf16 a[0:3], v[116:119], v[80:83], a[0:3]
    v_exp_f32 v64, v64
    v_mfma_f32_16x16x32_bf16 a[4:7], v[120:123], v[80:83], a[4:7]
    v_exp_f32 v65, v65
    v_mfma_f32_16x16x32_bf16 a[8:11], v[124:127], v[80:83], a[8:11]
    v_cvt_pk_bf16_f32 v78, v64, v65
    v_mfma_f32_16x16x32_bf16 a[12:15], v[128:131], v[80:83], a[12:15]
    buffer_load_dwordx4 v24, s[8:11], s37 offen offset:2048 lds
    s_waitcnt lgkmcnt(2)
    v_mfma_f32_16x16x32_bf16 a[16:19], v[132:135], v[80:83], a[16:19]
    v_exp_f32 v66, v66
    v_mfma_f32_16x16x32_bf16 a[20:23], v[136:139], v[80:83], a[20:23]
    v_exp_f32 v67, v67
    v_mfma_f32_16x16x32_bf16 a[24:27], v[140:143], v[80:83], a[24:27]
    s_waitcnt lgkmcnt(0)
    v_cvt_pk_bf16_f32 v79, v66, v67
    v_mfma_f32_16x16x32_bf16 a[28:31], v[144:147], v[80:83], a[28:31]
    v_mfma_f32_16x16x32_bf16 v[148:151], v[168:171], v[80:83], v[148:151]
    buffer_load_dwordx4 v25, s[8:11], s37 offen offset:3072 lds
    v_mfma_f32_16x16x32_bf16 v[60:63], v[84:87], a[208:211], v[52:55]
    s_add_u32 m0, s29, 24576
    v_exp_f32 v68, v68
    v_mfma_f32_16x16x32_bf16 v[60:63], v[88:91], a[212:215], v[60:63]
    v_exp_f32 v69, v69
    v_mfma_f32_16x16x32_bf16 v[60:63], v[92:95], a[216:219], v[60:63]
    v_cvt_pk_bf16_f32 v80, v68, v69
    v_mfma_f32_16x16x32_bf16 v[60:63], v[96:99], a[220:223], v[60:63]
    buffer_load_dwordx4 v26, s[12:15], s36 offen offset:0 lds
    v_mfma_f32_16x16x32_bf16 v[64:67], v[100:103], a[208:211], v[52:55]
    v_exp_f32 v70, v70
    v_mfma_f32_16x16x32_bf16 v[64:67], v[104:107], a[212:215], v[64:67]
    v_exp_f32 v71, v71
    v_mfma_f32_16x16x32_bf16 v[64:67], v[108:111], a[216:219], v[64:67]
    v_cvt_pk_bf16_f32 v81, v70, v71
    v_mfma_f32_16x16x32_bf16 v[64:67], v[112:115], a[220:223], v[64:67]
    buffer_load_dwordx4 v27, s[12:15], s36 offen offset:1024 lds
    v_mfma_f32_16x16x32_bf16 a[32:35], v[116:119], v[76:79], a[32:35]
    v_exp_f32 v72, v72
    v_mfma_f32_16x16x32_bf16 a[36:39], v[120:123], v[76:79], a[36:39]
    v_exp_f32 v73, v73
    v_mfma_f32_16x16x32_bf16 a[40:43], v[124:127], v[76:79], a[40:43]
    v_cvt_pk_bf16_f32 v82, v72, v73
    v_mfma_f32_16x16x32_bf16 a[44:47], v[128:131], v[76:79], a[44:47]
    buffer_load_dwordx4 v26, s[12:15], s36 offen offset:2048 lds
    v_mfma_f32_16x16x32_bf16 a[48:51], v[132:135], v[76:79], a[48:51]
    v_exp_f32 v74, v74
    v_mfma_f32_16x16x32_bf16 a[52:55], v[136:139], v[76:79], a[52:55]
    v_exp_f32 v75, v75
    v_mfma_f32_16x16x32_bf16 a[56:59], v[140:143], v[76:79], a[56:59]
    v_cvt_pk_bf16_f32 v83, v74, v75
    v_mfma_f32_16x16x32_bf16 a[60:63], v[144:147], v[76:79], a[60:63]
    buffer_load_dwordx4 v27, s[12:15], s36 offen offset:3072 lds
    v_mfma_f32_16x16x32_bf16 v[152:155], v[168:171], v[76:79], v[152:155]
    s_waitcnt vmcnt(20)
    v_mfma_f32_16x16x32_bf16 v[68:71], v[84:87], a[224:227], v[56:59]
    s_add_u32 m0, s29, 28672
    v_exp_f32 v60, v60
    v_mfma_f32_16x16x32_bf16 v[68:71], v[88:91], a[228:231], v[68:71]
    v_exp_f32 v61, v61
    v_mfma_f32_16x16x32_bf16 v[68:71], v[92:95], a[232:235], v[68:71]
    ds_read_b128 v[84:87], v10 offset:0
    v_cvt_pk_bf16_f32 v76, v60, v61
    v_mfma_f32_16x16x32_bf16 v[68:71], v[96:99], a[236:239], v[68:71]
    ds_read_b128 v[88:91], v11 offset:0
    ds_read_b128 v[92:95], v12 offset:0
    v_mfma_f32_16x16x32_bf16 v[72:75], v[100:103], a[224:227], v[56:59]
    buffer_load_dwordx4 v26, s[12:15], s37 offen offset:0 lds
    v_exp_f32 v62, v62
    v_mfma_f32_16x16x32_bf16 v[72:75], v[104:107], a[228:231], v[72:75]
    v_exp_f32 v63, v63
    v_mfma_f32_16x16x32_bf16 v[72:75], v[108:111], a[232:235], v[72:75]
    ds_read_b128 v[96:99], v13 offset:0
    v_cvt_pk_bf16_f32 v77, v62, v63
    v_mfma_f32_16x16x32_bf16 v[72:75], v[112:115], a[236:239], v[72:75]
    ds_read_b128 v[100:103], v10 offset:4096
    ds_read_b128 v[104:107], v11 offset:4096
    v_mfma_f32_16x16x32_bf16 a[64:67], v[116:119], v[80:83], a[64:67]
    buffer_load_dwordx4 v27, s[12:15], s37 offen offset:1024 lds
    v_exp_f32 v64, v64
    v_mfma_f32_16x16x32_bf16 a[68:71], v[120:123], v[80:83], a[68:71]
    v_exp_f32 v65, v65
    v_mfma_f32_16x16x32_bf16 a[72:75], v[124:127], v[80:83], a[72:75]
    ds_read_b128 v[108:111], v12 offset:4096
    v_cvt_pk_bf16_f32 v78, v64, v65
    v_mfma_f32_16x16x32_bf16 a[76:79], v[128:131], v[80:83], a[76:79]
    ds_read_b128 v[112:115], v13 offset:4096
    v_mfma_f32_16x16x32_bf16 a[80:83], v[132:135], v[80:83], a[80:83]
    buffer_load_dwordx4 v26, s[12:15], s37 offen offset:2048 lds
    v_exp_f32 v66, v66
    v_mfma_f32_16x16x32_bf16 a[84:87], v[136:139], v[80:83], a[84:87]
    v_exp_f32 v67, v67
    v_mfma_f32_16x16x32_bf16 a[88:91], v[140:143], v[80:83], a[88:91]
    v_cvt_pk_bf16_f32 v79, v66, v67
    v_mfma_f32_16x16x32_bf16 a[92:95], v[144:147], v[80:83], a[92:95]
    buffer_load_dwordx4 v27, s[12:15], s37 offen offset:3072 lds
    v_mfma_f32_16x16x32_bf16 v[156:159], v[168:171], v[80:83], v[156:159]
    s_waitcnt lgkmcnt(2)
    s_sub_u32 s38, s38, 1
    s_cmp_lg_u32 s38, 0
    s_cbranch_scc1 L_loop
    s_lshl_b32 s88, s24, 19
    s_lshl_b32 s61, s26, 8
    s_add_u32 s88, s88, s61
    v_mfma_f32_16x16x32_bf16 v[60:63], v[84:87], a[160:163], v[40:43]
    v_exp_f32 v68, v68
    v_mfma_f32_16x16x32_bf16 v[60:63], v[88:91], a[164:167], v[60:63]
    v_exp_f32 v69, v69
    v_mfma_f32_16x16x32_bf16 v[60:63], v[92:95], a[168:171], v[60:63]
    v_cvt_pk_bf16_f32 v80, v68, v69
    v_mfma_f32_16x16x32_bf16 v[60:63], v[96:99], a[172:175], v[60:63]
    v_mfma_f32_16x16x32_bf16 v[64:67], v[100:103], a[160:163], v[40:43]
    v_exp_f32 v70, v70
    v_mfma_f32_16x16x32_bf16 v[64:67], v[104:107], a[164:167], v[64:67]
    s_waitcnt lgkmcnt(0)
    v_exp_f32 v71, v71
    v_mfma_f32_16x16x32_bf16 v[64:67], v[108:111], a[168:171], v[64:67]
    v_cvt_pk_bf16_f32 v81, v70, v71
    v_mfma_f32_16x16x32_bf16 v[64:67], v[112:115], a[172:175], v[64:67]
    v_mfma_f32_16x16x32_bf16 a[96:99], v[116:119], v[76:79], a[96:99]
    v_exp_f32 v72, v72
    v_mfma_f32_16x16x32_bf16 a[100:103], v[120:123], v[76:79], a[100:103]
    v_exp_f32 v73, v73
    v_mfma_f32_16x16x32_bf16 a[104:107], v[124:127], v[76:79], a[104:107]
    v_cvt_pk_bf16_f32 v82, v72, v73
    v_mfma_f32_16x16x32_bf16 a[108:111], v[128:131], v[76:79], a[108:111]
    v_mfma_f32_16x16x32_bf16 a[112:115], v[132:135], v[76:79], a[112:115]
    v_exp_f32 v74, v74
    v_mfma_f32_16x16x32_bf16 a[116:119], v[136:139], v[76:79], a[116:119]
    v_exp_f32 v75, v75
    v_mfma_f32_16x16x32_bf16 a[120:123], v[140:143], v[76:79], a[120:123]
    v_cvt_pk_bf16_f32 v83, v74, v75
    v_mfma_f32_16x16x32_bf16 a[124:127], v[144:147], v[76:79], a[124:127]
    v_mfma_f32_16x16x32_bf16 v[160:163], v[168:171], v[76:79], v[160:163]
    v_mfma_f32_16x16x32_bf16 v[68:71], v[84:87], a[176:179], v[44:47]
    v_exp_f32 v60, v60
    v_mfma_f32_16x16x32_bf16 v[68:71], v[88:91], a[180:183], v[68:71]
    v_exp_f32 v61, v61
    v_mfma_f32_16x16x32_bf16 v[68:71], v[92:95], a[184:187], v[68:71]
    v_cvt_pk_bf16_f32 v76, v60, v61
    v_mfma_f32_16x16x32_bf16 v[68:71], v[96:99], a[188:191], v[68:71]
    v_mfma_f32_16x16x32_bf16 v[72:75], v[100:103], a[176:179], v[44:47]
    v_exp_f32 v62, v62
    v_mfma_f32_16x16x32_bf16 v[72:75], v[104:107], a[180:183], v[72:75]
    v_exp_f32 v63, v63
    v_mfma_f32_16x16x32_bf16 v[72:75], v[108:111], a[184:187], v[72:75]
    v_cvt_pk_bf16_f32 v77, v62, v63
    v_mfma_f32_16x16x32_bf16 v[72:75], v[112:115], a[188:191], v[72:75]
    v_mfma_f32_16x16x32_bf16 a[128:131], v[116:119], v[80:83], a[128:131]
    v_exp_f32 v64, v64
    v_mfma_f32_16x16x32_bf16 a[132:135], v[120:123], v[80:83], a[132:135]
    s_waitcnt vmcnt(16)
    v_exp_f32 v65, v65
    v_mfma_f32_16x16x32_bf16 a[136:139], v[124:127], v[80:83], a[136:139]
    ds_read_b64_tr_b16 v[116:117], v14 offset:16384
    v_cvt_pk_bf16_f32 v78, v64, v65
    v_mfma_f32_16x16x32_bf16 a[140:143], v[128:131], v[80:83], a[140:143]
    ds_read_b64_tr_b16 v[118:119], v14 offset:20480
    ds_read_b64_tr_b16 v[120:121], v15 offset:16384
    v_mfma_f32_16x16x32_bf16 a[144:147], v[132:135], v[80:83], a[144:147]
    v_exp_f32 v66, v66
    v_mfma_f32_16x16x32_bf16 a[148:151], v[136:139], v[80:83], a[148:151]
    v_exp_f32 v67, v67
    v_mfma_f32_16x16x32_bf16 a[152:155], v[140:143], v[80:83], a[152:155]
    ds_read_b64_tr_b16 v[122:123], v15 offset:20480
    v_cvt_pk_bf16_f32 v79, v66, v67
    v_mfma_f32_16x16x32_bf16 a[156:159], v[144:147], v[80:83], a[156:159]
    ds_read_b64_tr_b16 v[124:125], v16 offset:16384
    ds_read_b64_tr_b16 v[126:127], v16 offset:20480
    v_mfma_f32_16x16x32_bf16 v[164:167], v[168:171], v[80:83], v[164:167]
    ds_read_b64_tr_b16 v[128:129], v17 offset:16384
    ds_read_b64_tr_b16 v[130:131], v17 offset:20480
    v_mfma_f32_16x16x32_bf16 v[60:63], v[84:87], a[192:195], v[48:51]
    v_exp_f32 v68, v68
    v_mfma_f32_16x16x32_bf16 v[60:63], v[88:91], a[196:199], v[60:63]
    v_exp_f32 v69, v69
    v_mfma_f32_16x16x32_bf16 v[60:63], v[92:95], a[200:203], v[60:63]
    ds_read_b64_tr_b16 v[132:133], v18 offset:16384
    ds_read_b64_tr_b16 v[134:135], v18 offset:20480
    v_cvt_pk_bf16_f32 v80, v68, v69
    v_mfma_f32_16x16x32_bf16 v[60:63], v[96:99], a[204:207], v[60:63]
    ds_read_b64_tr_b16 v[136:137], v19 offset:16384
    ds_read_b64_tr_b16 v[138:139], v19 offset:20480
    v_mfma_f32_16x16x32_bf16 v[64:67], v[100:103], a[192:195], v[48:51]
    v_exp_f32 v70, v70
    v_mfma_f32_16x16x32_bf16 v[64:67], v[104:107], a[196:199], v[64:67]
    v_exp_f32 v71, v71
    v_mfma_f32_16x16x32_bf16 v[64:67], v[108:111], a[200:203], v[64:67]
    ds_read_b64_tr_b16 v[140:141], v20 offset:16384
    ds_read_b64_tr_b16 v[142:143], v20 offset:20480
    v_cvt_pk_bf16_f32 v81, v70, v71
    v_mfma_f32_16x16x32_bf16 v[64:67], v[112:115], a[204:207], v[64:67]
    ds_read_b64_tr_b16 v[144:145], v21 offset:16384
    ds_read_b64_tr_b16 v[146:147], v21 offset:20480
    s_waitcnt lgkmcnt(8)
    v_mfma_f32_16x16x32_bf16 a[0:3], v[116:119], v[76:79], a[0:3]
    v_exp_f32 v72, v72
    v_mfma_f32_16x16x32_bf16 a[4:7], v[120:123], v[76:79], a[4:7]
    v_exp_f32 v73, v73
    v_mfma_f32_16x16x32_bf16 a[8:11], v[124:127], v[76:79], a[8:11]
    v_cvt_pk_bf16_f32 v82, v72, v73
    v_mfma_f32_16x16x32_bf16 a[12:15], v[128:131], v[76:79], a[12:15]
    s_waitcnt lgkmcnt(2)
    v_mfma_f32_16x16x32_bf16 a[16:19], v[132:135], v[76:79], a[16:19]
    v_exp_f32 v74, v74
    v_mfma_f32_16x16x32_bf16 a[20:23], v[136:139], v[76:79], a[20:23]
    v_exp_f32 v75, v75
    v_mfma_f32_16x16x32_bf16 a[24:27], v[140:143], v[76:79], a[24:27]
    s_waitcnt lgkmcnt(0)
    v_cvt_pk_bf16_f32 v83, v74, v75
    v_mfma_f32_16x16x32_bf16 a[28:31], v[144:147], v[76:79], a[28:31]
    v_mfma_f32_16x16x32_bf16 v[148:151], v[168:171], v[76:79], v[148:151]
    v_mfma_f32_16x16x32_bf16 v[68:71], v[84:87], a[208:211], v[52:55]
    v_exp_f32 v60, v60
    v_mfma_f32_16x16x32_bf16 v[68:71], v[88:91], a[212:215], v[68:71]
    v_exp_f32 v61, v61
    v_mfma_f32_16x16x32_bf16 v[68:71], v[92:95], a[216:219], v[68:71]
    v_cvt_pk_bf16_f32 v76, v60, v61
    v_mfma_f32_16x16x32_bf16 v[68:71], v[96:99], a[220:223], v[68:71]
    v_mfma_f32_16x16x32_bf16 v[72:75], v[100:103], a[208:211], v[52:55]
    v_exp_f32 v62, v62
    v_mfma_f32_16x16x32_bf16 v[72:75], v[104:107], a[212:215], v[72:75]
    v_exp_f32 v63, v63
    v_mfma_f32_16x16x32_bf16 v[72:75], v[108:111], a[216:219], v[72:75]
    v_cvt_pk_bf16_f32 v77, v62, v63
    v_mfma_f32_16x16x32_bf16 v[72:75], v[112:115], a[220:223], v[72:75]
    v_mfma_f32_16x16x32_bf16 a[32:35], v[116:119], v[80:83], a[32:35]
    v_exp_f32 v64, v64
    v_mfma_f32_16x16x32_bf16 a[36:39], v[120:123], v[80:83], a[36:39]
    v_exp_f32 v65, v65
    v_mfma_f32_16x16x32_bf16 a[40:43], v[124:127], v[80:83], a[40:43]
    v_cvt_pk_bf16_f32 v78, v64, v65
    v_mfma_f32_16x16x32_bf16 a[44:47], v[128:131], v[80:83], a[44:47]
    v_mfma_f32_16x16x32_bf16 a[48:51], v[132:135], v[80:83], a[48:51]
    v_exp_f32 v66, v66
    v_mfma_f32_16x16x32_bf16 a[52:55], v[136:139], v[80:83], a[52:55]
    v_exp_f32 v67, v67
    v_mfma_f32_16x16x32_bf16 a[56:59], v[140:143], v[80:83], a[56:59]
    v_cvt_pk_bf16_f32 v79, v66, v67
    v_mfma_f32_16x16x32_bf16 a[60:63], v[144:147], v[80:83], a[60:63]
    v_mfma_f32_16x16x32_bf16 v[152:155], v[168:171], v[80:83], v[152:155]
    s_waitcnt vmcnt(8)
    v_mfma_f32_16x16x32_bf16 v[60:63], v[84:87], a[224:227], v[56:59]
    v_exp_f32 v68, v68
    v_mfma_f32_16x16x32_bf16 v[60:63], v[88:91], a[228:231], v[60:63]
    v_exp_f32 v69, v69
    v_mfma_f32_16x16x32_bf16 v[60:63], v[92:95], a[232:235], v[60:63]
    ds_read_b128 v[84:87], v10 offset:8192
    v_cvt_pk_bf16_f32 v80, v68, v69
    v_mfma_f32_16x16x32_bf16 v[60:63], v[96:99], a[236:239], v[60:63]
    ds_read_b128 v[88:91], v11 offset:8192
    ds_read_b128 v[92:95], v12 offset:8192
    v_mfma_f32_16x16x32_bf16 v[64:67], v[100:103], a[224:227], v[56:59]
    v_exp_f32 v70, v70
    v_mfma_f32_16x16x32_bf16 v[64:67], v[104:107], a[228:231], v[64:67]
    v_exp_f32 v71, v71
    v_mfma_f32_16x16x32_bf16 v[64:67], v[108:111], a[232:235], v[64:67]
    ds_read_b128 v[96:99], v13 offset:8192
    v_cvt_pk_bf16_f32 v81, v70, v71
    v_mfma_f32_16x16x32_bf16 v[64:67], v[112:115], a[236:239], v[64:67]
    ds_read_b128 v[100:103], v10 offset:12288
    ds_read_b128 v[104:107], v11 offset:12288
    v_mfma_f32_16x16x32_bf16 a[64:67], v[116:119], v[76:79], a[64:67]
    v_exp_f32 v72, v72
    v_mfma_f32_16x16x32_bf16 a[68:71], v[120:123], v[76:79], a[68:71]
    v_exp_f32 v73, v73
    v_mfma_f32_16x16x32_bf16 a[72:75], v[124:127], v[76:79], a[72:75]
    ds_read_b128 v[108:111], v12 offset:12288
    v_cvt_pk_bf16_f32 v82, v72, v73
    v_mfma_f32_16x16x32_bf16 a[76:79], v[128:131], v[76:79], a[76:79]
    ds_read_b128 v[112:115], v13 offset:12288
    v_mfma_f32_16x16x32_bf16 a[80:83], v[132:135], v[76:79], a[80:83]
    v_exp_f32 v74, v74
    v_mfma_f32_16x16x32_bf16 a[84:87], v[136:139], v[76:79], a[84:87]
    v_exp_f32 v75, v75
    v_mfma_f32_16x16x32_bf16 a[88:91], v[140:143], v[76:79], a[88:91]
    v_cvt_pk_bf16_f32 v83, v74, v75
    v_mfma_f32_16x16x32_bf16 a[92:95], v[144:147], v[76:79], a[92:95]
    v_mfma_f32_16x16x32_bf16 v[156:159], v[168:171], v[76:79], v[156:159]
    s_waitcnt lgkmcnt(2)
    v_mfma_f32_16x16x32_bf16 v[68:71], v[84:87], a[160:163], v[40:43]
    v_exp_f32 v60, v60
    v_mfma_f32_16x16x32_bf16 v[68:71], v[88:91], a[164:167], v[68:71]
    v_exp_f32 v61, v61
    v_mfma_f32_16x16x32_bf16 v[68:71], v[92:95], a[168:171], v[68:71]
    v_cvt_pk_bf16_f32 v76, v60, v61
    v_mfma_f32_16x16x32_bf16 v[68:71], v[96:99], a[172:175], v[68:71]
    v_mfma_f32_16x16x32_bf16 v[72:75], v[100:103], a[160:163], v[40:43]
    v_exp_f32 v62, v62
    v_mfma_f32_16x16x32_bf16 v[72:75], v[104:107], a[164:167], v[72:75]
    s_waitcnt lgkmcnt(0)
    v_exp_f32 v63, v63
    v_mfma_f32_16x16x32_bf16 v[72:75], v[108:111], a[168:171], v[72:75]
    v_cvt_pk_bf16_f32 v77, v62, v63
    v_mfma_f32_16x16x32_bf16 v[72:75], v[112:115], a[172:175], v[72:75]
    v_mfma_f32_16x16x32_bf16 a[96:99], v[116:119], v[80:83], a[96:99]
    v_exp_f32 v64, v64
    v_mfma_f32_16x16x32_bf16 a[100:103], v[120:123], v[80:83], a[100:103]
    v_exp_f32 v65, v65
    v_mfma_f32_16x16x32_bf16 a[104:107], v[124:127], v[80:83], a[104:107]
    v_cvt_pk_bf16_f32 v78, v64, v65
    v_mfma_f32_16x16x32_bf16 a[108:111], v[128:131], v[80:83], a[108:111]
    v_mfma_f32_16x16x32_bf16 a[112:115], v[132:135], v[80:83], a[112:115]
    v_exp_f32 v66, v66
    v_mfma_f32_16x16x32_bf16 a[116:119], v[136:139], v[80:83], a[116:119]
    v_exp_f32 v67, v67
    v_mfma_f32_16x16x32_bf16 a[120:123], v[140:143], v[80:83], a[120:123]
    v_cvt_pk_bf16_f32 v79, v66, v67
    v_mfma_f32_16x16x32_bf16 a[124:127], v[144:147], v[80:83], a[124:127]
    v_mfma_f32_16x16x32_bf16 v[160:163], v[168:171], v[80:83], v[160:163]
    v_mfma_f32_16x16x32_bf16 v[60:63], v[84:87], a[176:179], v[44:47]
    v_exp_f32 v68, v68
    v_mfma_f32_16x16x32_bf16 v[60:63], v[88:91], a[180:183], v[60:63]
    v_exp_f32 v69, v69
    v_mfma_f32_16x16x32_bf16 v[60:63], v[92:95], a[184:187], v[60:63]
    v_cvt_pk_bf16_f32 v80, v68, v69
    v_mfma_f32_16x16x32_bf16 v[60:63], v[96:99], a[188:191], v[60:63]
    v_mfma_f32_16x16x32_bf16 v[64:67], v[100:103], a[176:179], v[44:47]
    v_exp_f32 v70, v70
    v_mfma_f32_16x16x32_bf16 v[64:67], v[104:107], a[180:183], v[64:67]
    v_exp_f32 v71, v71
    v_mfma_f32_16x16x32_bf16 v[64:67], v[108:111], a[184:187], v[64:67]
    v_cvt_pk_bf16_f32 v81, v70, v71
    v_mfma_f32_16x16x32_bf16 v[64:67], v[112:115], a[188:191], v[64:67]
    v_mfma_f32_16x16x32_bf16 a[128:131], v[116:119], v[76:79], a[128:131]
    v_exp_f32 v72, v72
    v_mfma_f32_16x16x32_bf16 a[132:135], v[120:123], v[76:79], a[132:135]
    s_waitcnt vmcnt(0)
    v_exp_f32 v73, v73
    v_mfma_f32_16x16x32_bf16 a[136:139], v[124:127], v[76:79], a[136:139]
    ds_read_b64_tr_b16 v[116:117], v14 offset:24576
    v_cvt_pk_bf16_f32 v82, v72, v73
    v_mfma_f32_16x16x32_bf16 a[140:143], v[128:131], v[76:79], a[140:143]
    ds_read_b64_tr_b16 v[118:119], v14 offset:28672
    ds_read_b64_tr_b16 v[120:121], v15 offset:24576
    v_mfma_f32_16x16x32_bf16 a[144:147], v[132:135], v[76:79], a[144:147]
    v_exp_f32 v74, v74
    v_mfma_f32_16x16x32_bf16 a[148:151], v[136:139], v[76:79], a[148:151]
    v_exp_f32 v75, v75
    v_mfma_f32_16x16x32_bf16 a[152:155], v[140:143], v[76:79], a[152:155]
    ds_read_b64_tr_b16 v[122:123], v15 offset:28672
    v_cvt_pk_bf16_f32 v83, v74, v75
    v_mfma_f32_16x16x32_bf16 a[156:159], v[144:147], v[76:79], a[156:159]
    ds_read_b64_tr_b16 v[124:125], v16 offset:24576
    ds_read_b64_tr_b16 v[126:127], v16 offset:28672
    v_mfma_f32_16x16x32_bf16 v[164:167], v[168:171], v[76:79], v[164:167]
    ds_read_b64_tr_b16 v[128:129], v17 offset:24576
    ds_read_b64_tr_b16 v[130:131], v17 offset:28672
    v_mfma_f32_16x16x32_bf16 v[68:71], v[84:87], a[192:195], v[48:51]
    v_exp_f32 v60, v60
    v_mfma_f32_16x16x32_bf16 v[68:71], v[88:91], a[196:199], v[68:71]
    v_exp_f32 v61, v61
    v_mfma_f32_16x16x32_bf16 v[68:71], v[92:95], a[200:203], v[68:71]
    ds_read_b64_tr_b16 v[132:133], v18 offset:24576
    ds_read_b64_tr_b16 v[134:135], v18 offset:28672
    v_cvt_pk_bf16_f32 v76, v60, v61
    v_mfma_f32_16x16x32_bf16 v[68:71], v[96:99], a[204:207], v[68:71]
    ds_read_b64_tr_b16 v[136:137], v19 offset:24576
    ds_read_b64_tr_b16 v[138:139], v19 offset:28672
    s_lshl_b32 s60, s26, 1
    s_add_u32 s60, s60, 0
    s_and_b32 s60, s60, 7
    s_lshl_b32 s60, s60, 16
    s_add_u32 s41, s60, s88
    s_add_u32 m0, s39, 131072
    s_add_u32 s60, s41, 0
    buffer_load_dwordx4 v247, s[44:47], s60 offen lds
    v_mfma_f32_16x16x32_bf16 v[72:75], v[100:103], a[192:195], v[48:51]
    v_exp_f32 v62, v62
    v_mfma_f32_16x16x32_bf16 v[72:75], v[104:107], a[196:199], v[72:75]
    v_exp_f32 v63, v63
    v_mfma_f32_16x16x32_bf16 v[72:75], v[108:111], a[200:203], v[72:75]
    ds_read_b64_tr_b16 v[140:141], v20 offset:24576
    ds_read_b64_tr_b16 v[142:143], v20 offset:28672
    v_cvt_pk_bf16_f32 v77, v62, v63
    v_mfma_f32_16x16x32_bf16 v[72:75], v[112:115], a[204:207], v[72:75]
    ds_read_b64_tr_b16 v[144:145], v21 offset:24576
    ds_read_b64_tr_b16 v[146:147], v21 offset:28672
    s_waitcnt lgkmcnt(8)
    s_add_u32 m0, s39, 135168
    s_add_u32 s60, s41, 16384
    buffer_load_dwordx4 v247, s[44:47], s60 offen lds
    v_mfma_f32_16x16x32_bf16 a[0:3], v[116:119], v[80:83], a[0:3]
    v_exp_f32 v64, v64
    v_mfma_f32_16x16x32_bf16 a[4:7], v[120:123], v[80:83], a[4:7]
    v_exp_f32 v65, v65
    v_mfma_f32_16x16x32_bf16 a[8:11], v[124:127], v[80:83], a[8:11]
    v_cvt_pk_bf16_f32 v78, v64, v65
    v_mfma_f32_16x16x32_bf16 a[12:15], v[128:131], v[80:83], a[12:15]
    s_waitcnt lgkmcnt(2)
    s_add_u32 m0, s39, 139264
    s_add_u32 s60, s41, 32768
    buffer_load_dwordx4 v247, s[44:47], s60 offen lds
    v_mfma_f32_16x16x32_bf16 a[16:19], v[132:135], v[80:83], a[16:19]
    v_exp_f32 v66, v66
    v_mfma_f32_16x16x32_bf16 a[20:23], v[136:139], v[80:83], a[20:23]
    v_exp_f32 v67, v67
    v_mfma_f32_16x16x32_bf16 a[24:27], v[140:143], v[80:83], a[24:27]
    s_waitcnt lgkmcnt(0)
    v_cvt_pk_bf16_f32 v79, v66, v67
    v_mfma_f32_16x16x32_bf16 a[28:31], v[144:147], v[80:83], a[28:31]
    s_add_u32 m0, s39, 143360
    s_add_u32 s60, s41, 49152
    buffer_load_dwordx4 v247, s[44:47], s60 offen lds
    v_mfma_f32_16x16x32_bf16 v[148:151], v[168:171], v[80:83], v[148:151]
    v_mfma_f32_16x16x32_bf16 v[60:63], v[84:87], a[208:211], v[52:55]
    v_exp_f32 v68, v68
    v_mfma_f32_16x16x32_bf16 v[60:63], v[88:91], a[212:215], v[60:63]
    v_exp_f32 v69, v69
    v_mfma_f32_16x16x32_bf16 v[60:63], v[92:95], a[216:219], v[60:63]
    v_cvt_pk_bf16_f32 v80, v68, v69
    v_mfma_f32_16x16x32_bf16 v[60:63], v[96:99], a[220:223], v[60:63]
    s_lshl_b32 s60, s26, 1
    s_add_u32 s60, s60, 1
    s_and_b32 s60, s60, 7
    s_lshl_b32 s60, s60, 16
    s_add_u32 s41, s60, s88
    s_add_u32 m0, s39, 147456
    s_add_u32 s60, s41, 0
    buffer_load_dwordx4 v247, s[44:47], s60 offen lds
    v_mfma_f32_16x16x32_bf16 v[64:67], v[100:103], a[208:211], v[52:55]
    v_exp_f32 v70, v70
    v_mfma_f32_16x16x32_bf16 v[64:67], v[104:107], a[212:215], v[64:67]
    v_exp_f32 v71, v71
    v_mfma_f32_16x16x32_bf16 v[64:67], v[108:111], a[216:219], v[64:67]
    v_cvt_pk_bf16_f32 v81, v70, v71
    v_mfma_f32_16x16x32_bf16 v[64:67], v[112:115], a[220:223], v[64:67]
    s_add_u32 m0, s39, 151552
    s_add_u32 s60, s41, 16384
    buffer_load_dwordx4 v247, s[44:47], s60 offen lds
    v_mfma_f32_16x16x32_bf16 a[32:35], v[116:119], v[76:79], a[32:35]
    v_exp_f32 v72, v72
    v_mfma_f32_16x16x32_bf16 a[36:39], v[120:123], v[76:79], a[36:39]
    v_exp_f32 v73, v73
    v_mfma_f32_16x16x32_bf16 a[40:43], v[124:127], v[76:79], a[40:43]
    v_cvt_pk_bf16_f32 v82, v72, v73
    v_mfma_f32_16x16x32_bf16 a[44:47], v[128:131], v[76:79], a[44:47]
    s_add_u32 m0, s39, 155648
    s_add_u32 s60, s41, 32768
    buffer_load_dwordx4 v247, s[44:47], s60 offen lds
    v_mfma_f32_16x16x32_bf16 a[48:51], v[132:135], v[76:79], a[48:51]
    v_exp_f32 v74, v74
    v_mfma_f32_16x16x32_bf16 a[52:55], v[136:139], v[76:79], a[52:55]
    v_exp_f32 v75, v75
    v_mfma_f32_16x16x32_bf16 a[56:59], v[140:143], v[76:79], a[56:59]
    v_cvt_pk_bf16_f32 v83, v74, v75
    v_mfma_f32_16x16x32_bf16 a[60:63], v[144:147], v[76:79], a[60:63]
    s_add_u32 m0, s39, 159744
    s_add_u32 s60, s41, 49152
    buffer_load_dwordx4 v247, s[44:47], s60 offen lds
    v_mfma_f32_16x16x32_bf16 v[152:155], v[168:171], v[76:79], v[152:155]
    v_mfma_f32_16x16x32_bf16 v[68:71], v[84:87], a[224:227], v[56:59]
    v_exp_f32 v60, v60
    v_mfma_f32_16x16x32_bf16 v[68:71], v[88:91], a[228:231], v[68:71]
    v_exp_f32 v61, v61
    v_mfma_f32_16x16x32_bf16 v[68:71], v[92:95], a[232:235], v[68:71]
    v_cvt_pk_bf16_f32 v76, v60, v61
    v_mfma_f32_16x16x32_bf16 v[68:71], v[96:99], a[236:239], v[68:71]
    s_lshl_b32 s62, s25, 5
    buffer_load_dwordx4 v[248:251], off, s[56:59], s62 sc1
    v_mfma_f32_16x16x32_bf16 v[72:75], v[100:103], a[224:227], v[56:59]
    v_exp_f32 v62, v62
    v_mfma_f32_16x16x32_bf16 v[72:75], v[104:107], a[228:231], v[72:75]
    v_exp_f32 v63, v63
    v_mfma_f32_16x16x32_bf16 v[72:75], v[108:111], a[232:235], v[72:75]
    v_cvt_pk_bf16_f32 v77, v62, v63
    v_mfma_f32_16x16x32_bf16 v[72:75], v[112:115], a[236:239], v[72:75]
    buffer_load_dwordx4 v[252:255], off, s[56:59], s62 offset:16 sc1
    v_mfma_f32_16x16x32_bf16 a[64:67], v[116:119], v[80:83], a[64:67]
    v_exp_f32 v64, v64
    v_mfma_f32_16x16x32_bf16 a[68:71], v[120:123], v[80:83], a[68:71]
    v_exp_f32 v65, v65
    v_mfma_f32_16x16x32_bf16 a[72:75], v[124:127], v[80:83], a[72:75]
    v_cvt_pk_bf16_f32 v78, v64, v65
    v_mfma_f32_16x16x32_bf16 a[76:79], v[128:131], v[80:83], a[76:79]
    v_mfma_f32_16x16x32_bf16 a[80:83], v[132:135], v[80:83], a[80:83]
    v_exp_f32 v66, v66
    v_mfma_f32_16x16x32_bf16 a[84:87], v[136:139], v[80:83], a[84:87]
    v_exp_f32 v67, v67
    v_mfma_f32_16x16x32_bf16 a[88:91], v[140:143], v[80:83], a[88:91]
    v_cvt_pk_bf16_f32 v79, v66, v67
    v_mfma_f32_16x16x32_bf16 a[92:95], v[144:147], v[80:83], a[92:95]
    v_mfma_f32_16x16x32_bf16 v[156:159], v[168:171], v[80:83], v[156:159]
    s_lshl_b32 s30, s25, 7
    s_lshl_b32 s31, s24, 4
    s_add_u32 s30, s30, s31
    s_mul_i32 s83, s30, 5120
    s_barrier
    s_add_u32 s30, s27, 1
    s_and_b32 s30, s30, 3
    s_mul_i32 s30, s30, 30720
    s_add_u32 s30, s30, 0
    v_add_u32 v236, s30, v38
    s_add_u32 s30, s27, 2
    s_and_b32 s30, s30, 3
    s_mul_i32 s30, s30, 30720
    s_add_u32 s30, s30, 10240
    v_add_u32 v237, s30, v38
    s_add_u32 s30, s27, 3
    s_and_b32 s30, s30, 3
    s_mul_i32 s30, s30, 30720
    s_add_u32 s30, s30, 20480
    v_add_u32 v238, s30, v38
    v_lshlrev_b32 v8, 2, v1
    s_mul_i32 s30, s27, 1280
    s_add_u32 s30, s30, 122880
    v_add_u32 v239, s30, v8
    v_exp_f32 v68, v68
    ds_write_b128 v236, a[8:11] offset:0
    ds_write_b128 v236, a[12:15] offset:1024
    v_exp_f32 v69, v69
    s_nop 0
    ds_write_b128 v237, a[16:19] offset:0
    ds_write_b128 v237, a[20:23] offset:1024
    v_cvt_pk_bf16_f32 v80, v68, v69
    ds_write_b128 v238, a[24:27] offset:0
    ds_write_b128 v238, a[28:31] offset:1024
    v_accvgpr_read_b32 v176, a0
    v_accvgpr_read_b32 v177, a1
    v_exp_f32 v70, v70
    v_accvgpr_read_b32 v178, a2
    v_accvgpr_read_b32 v179, a3
    v_exp_f32 v71, v71
    s_nop 0
    v_accvgpr_read_b32 v180, a4
    v_accvgpr_read_b32 v181, a5
    v_cvt_pk_bf16_f32 v81, v70, v71
    v_accvgpr_read_b32 v182, a6
    v_accvgpr_read_b32 v183, a7
    ds_write_b128 v236, a[40:43] offset:2048
    ds_write_b128 v236, a[44:47] offset:3072
    v_mfma_f32_16x16x32_bf16 a[96:99], v[116:119], v[76:79], a[96:99]
    v_exp_f32 v72, v72
    ds_write_b128 v237, a[48:51] offset:2048
    ds_write_b128 v237, a[52:55] offset:3072
    v_mfma_f32_16x16x32_bf16 a[100:103], v[120:123], v[76:79], a[100:103]
    v_exp_f32 v73, v73
    ds_write_b128 v238, a[56:59] offset:2048
    ds_write_b128 v238, a[60:63] offset:3072
    v_mfma_f32_16x16x32_bf16 a[104:107], v[124:127], v[76:79], a[104:107]
    v_cvt_pk_bf16_f32 v82, v72, v73
    v_accvgpr_read_b32 v184, a32
    v_accvgpr_read_b32 v185, a33
    v_mfma_f32_16x16x32_bf16 a[108:111], v[128:131], v[76:79], a[108:111]
    v_accvgpr_read_b32 v186, a34
    v_accvgpr_read_b32 v187, a35
    v_mfma_f32_16x16x32_bf16 a[112:115], v[132:135], v[76:79], a[112:115]
    v_exp_f32 v74, v74
    v_accvgpr_read_b32 v188, a36
    v_accvgpr_read_b32 v189, a37
    v_mfma_f32_16x16x32_bf16 a[116:119], v[136:139], v[76:79], a[116:119]
    v_exp_f32 v75, v75
    v_accvgpr_read_b32 v190, a38
    v_accvgpr_read_b32 v191, a39
    v_mfma_f32_16x16x32_bf16 a[120:123], v[140:143], v[76:79], a[120:123]
    v_cvt_pk_bf16_f32 v83, v74, v75
    ds_write_b128 v236, a[72:75] offset:4096
    ds_write_b128 v236, a[76:79] offset:5120
    v_mfma_f32_16x16x32_bf16 a[124:127], v[144:147], v[76:79], a[124:127]
    ds_write_b128 v237, a[80:83] offset:4096
    ds_write_b128 v237, a[84:87] offset:5120
    v_mfma_f32_16x16x32_bf16 v[160:163], v[168:171], v[76:79], v[160:163]
    ds_write_b128 v238, a[88:91] offset:4096
    ds_write_b128 v238, a[92:95] offset:5120
    s_nop 1
    v_mfma_f32_16x16x32_bf16 a[128:131], v[116:119], v[80:83], a[128:131]
    v_accvgpr_read_b32 v192, a64
    v_mfma_f32_16x16x32_bf16 a[132:135], v[120:123], v[80:83], a[132:135]
    v_accvgpr_read_b32 v193, a65
    v_mfma_f32_16x16x32_bf16 a[136:139], v[124:127], v[80:83], a[136:139]
    v_accvgpr_read_b32 v194, a66
    v_mfma_f32_16x16x32_bf16 a[140:143], v[128:131], v[80:83], a[140:143]
    v_accvgpr_read_b32 v195, a67
    v_mfma_f32_16x16x32_bf16 a[144:147], v[132:135], v[80:83], a[144:147]
    v_accvgpr_read_b32 v196, a68
    v_mfma_f32_16x16x32_bf16 a[148:151], v[136:139], v[80:83], a[148:151]
    v_accvgpr_read_b32 v197, a69
    v_mfma_f32_16x16x32_bf16 a[152:155], v[140:143], v[80:83], a[152:155]
    v_accvgpr_read_b32 v198, a70
    v_mfma_f32_16x16x32_bf16 a[156:159], v[144:147], v[80:83], a[156:159]
    v_accvgpr_read_b32 v199, a71
    v_mfma_f32_16x16x32_bf16 v[164:167], v[168:171], v[80:83], v[164:167]
    ds_write_b128 v236, a[104:107] offset:6144
    ds_write_b128 v236, a[108:111] offset:7168
    ds_write_b128 v237, a[112:115] offset:6144
    ds_write_b128 v237, a[116:119] offset:7168
    ds_write_b128 v238, a[120:123] offset:6144
    ds_write_b128 v238, a[124:127] offset:7168
    v_accvgpr_read_b32 v200, a96
    v_accvgpr_read_b32 v201, a97
    v_accvgpr_read_b32 v202, a98
    v_accvgpr_read_b32 v203, a99
    v_accvgpr_read_b32 v204, a100
    v_accvgpr_read_b32 v205, a101
    v_accvgpr_read_b32 v206, a102
    v_accvgpr_read_b32 v207, a103
    s_nop 3
    ds_write_b128 v236, a[136:139] offset:8192
    ds_write_b128 v236, a[140:143] offset:9216
    ds_write_b128 v237, a[144:147] offset:8192
    ds_write_b128 v237, a[148:151] offset:9216
    ds_write_b128 v238, a[152:155] offset:8192
    ds_write_b128 v238, a[156:159] offset:9216
    v_accvgpr_read_b32 v208, a128
    v_accvgpr_read_b32 v209, a129
    v_accvgpr_read_b32 v210, a130
    v_accvgpr_read_b32 v211, a131
    v_accvgpr_read_b32 v212, a132
    v_accvgpr_read_b32 v213, a133
    v_accvgpr_read_b32 v214, a134
    v_accvgpr_read_b32 v215, a135
    ds_write_b32 v239, v148 offset:0
    ds_write_b32 v239, v152 offset:256
    ds_write_b32 v239, v156 offset:512
    ds_write_b32 v239, v160 offset:768
    ds_write_b32 v239, v164 offset:1024
L_comb2:
    s_waitcnt lgkmcnt(0)
    s_barrier
    v_add_u32 v9, 122880, v8
    ds_read_b32 v216, v9 offset:0
    ds_read_b32 v217, v9 offset:256
    ds_read_b32 v218, v9 offset:512
    ds_read_b32 v219, v9 offset:768
    ds_read_b32 v220, v9 offset:1024
    ds_read_b32 v221, v9 offset:1280
    ds_read_b32 v222, v9 offset:1536
    ds_read_b32 v223, v9 offset:1792
    ds_read_b32 v224, v9 offset:2048
    ds_read_b32 v225, v9 offset:2304
    ds_read_b32 v226, v9 offset:2560
    ds_read_b32 v227, v9 offset:2816
    ds_read_b32 v228, v9 offset:3072
    ds_read_b32 v229, v9 offset:3328
    ds_read_b32 v230, v9 offset:3584
    ds_read_b32 v231, v9 offset:3840
    ds_read_b32 v232, v9 offset:4096
    ds_read_b32 v233, v9 offset:4352
    ds_read_b32 v234, v9 offset:4608
    ds_read_b32 v235, v9 offset:4864
    s_mul_i32 s30, s27, 30720
    v_add_u32 v9, s30, v38
    ds_read_b128 v[60:63], v9 offset:0
    ds_read_b128 v[64:67], v9 offset:10240
    ds_read_b128 v[68:71], v9 offset:20480
    ds_read_b128 v[72:75], v9 offset:1024
    ds_read_b128 v[76:79], v9 offset:11264
    ds_read_b128 v[80:83], v9 offset:21504
    ds_read_b128 v[84:87], v9 offset:2048
    ds_read_b128 v[88:91], v9 offset:12288
    ds_read_b128 v[92:95], v9 offset:22528
    s_waitcnt lgkmcnt(9)
    v_add_f32 v216, v216, v221
    v_add_f32 v226, v226, v231
    v_add_f32 v217, v217, v222
    v_add_f32 v227, v227, v232
    v_add_f32 v218, v218, v223
    v_add_f32 v228, v228, v233
    v_add_f32 v219, v219, v224
    v_add_f32 v229, v229, v234
    v_add_f32 v220, v220, v225
    v_add_f32 v230, v230, v235
    v_add_f32 v216, v216, v226
    v_add_f32 v217, v217, v227
    v_add_f32 v218, v218, v228
    v_add_f32 v219, v219, v229
    v_add_f32 v220, v220, v230
    v_add_f32 v225, v216, v217
    v_add_f32 v225, v225, v218
    v_add_f32 v225, v225, v219
    v_add_f32 v225, v225, v220
    s_mov_b32 s30, 0x53800000
    v_cmp_ngt_f32 s[90:91], s30, v225
    v_rcp_f32 v120, v216
    v_rcp_f32 v122, v217
    v_rcp_f32 v124, v218
    v_rcp_f32 v126, v219
    v_rcp_f32 v128, v220
    ds_read_b128 v[96:99], v9 offset:3072
    ds_read_b128 v[100:103], v9 offset:13312
    ds_read_b128 v[104:107], v9 offset:23552
    s_waitcnt lgkmcnt(9)
    v_pk_add_f32 v[176:177], v[176:177], v[60:61]
    v_pk_add_f32 v[178:179], v[178:179], v[62:63]
    v_pk_add_f32 v[176:177], v[176:177], v[64:65]
    v_pk_add_f32 v[178:179], v[178:179], v[66:67]
    v_pk_add_f32 v[176:177], v[176:177], v[68:69]
    v_pk_add_f32 v[178:179], v[178:179], v[70:71]
    v_pk_mul_f32 v[176:177], v[176:177], v[120:121] op_sel_hi:[1,0]
    v_pk_mul_f32 v[178:179], v[178:179], v[120:121] op_sel_hi:[1,0]
    ds_read_b128 v[108:111], v9 offset:4096
    ds_read_b128 v[112:115], v9 offset:14336
    ds_read_b128 v[116:119], v9 offset:24576
    s_waitcnt lgkmcnt(9)
    v_pk_add_f32 v[180:181], v[180:181], v[72:73]
    v_pk_add_f32 v[182:183], v[182:183], v[74:75]
    v_pk_add_f32 v[180:181], v[180:181], v[76:77]
    v_pk_add_f32 v[182:183], v[182:183], v[78:79]
    v_pk_add_f32 v[180:181], v[180:181], v[80:81]
    v_pk_add_f32 v[182:183], v[182:183], v[82:83]
    v_pk_mul_f32 v[180:181], v[180:181], v[120:121] op_sel_hi:[1,0]
    v_pk_mul_f32 v[182:183], v[182:183], v[120:121] op_sel_hi:[1,0]
    ds_read_b128 v[60:63], v9 offset:5120
    ds_read_b128 v[64:67], v9 offset:15360
    ds_read_b128 v[68:71], v9 offset:25600
    s_waitcnt lgkmcnt(9)
    v_pk_add_f32 v[184:185], v[184:185], v[84:85]
    v_pk_add_f32 v[186:187], v[186:187], v[86:87]
    v_pk_add_f32 v[184:185], v[184:185], v[88:89]
    v_pk_add_f32 v[186:187], v[186:187], v[90:91]
    v_pk_add_f32 v[184:185], v[184:185], v[92:93]
    v_pk_add_f32 v[186:187], v[186:187], v[94:95]
    v_pk_mul_f32 v[184:185], v[184:185], v[122:123] op_sel_hi:[1,0]
    v_pk_mul_f32 v[186:187], v[186:187], v[122:123] op_sel_hi:[1,0]
    ds_read_b128 v[72:75], v9 offset:6144
    ds_read_b128 v[76:79], v9 offset:16384
    ds_read_b128 v[80:83], v9 offset:26624
    s_waitcnt lgkmcnt(9)
    v_pk_add_f32 v[188:189], v[188:189], v[96:97]
    v_pk_add_f32 v[190:191], v[190:191], v[98:99]
    v_pk_add_f32 v[188:189], v[188:189], v[100:101]
    v_pk_add_f32 v[190:191], v[190:191], v[102:103]
    v_pk_add_f32 v[188:189], v[188:189], v[104:105]
    v_pk_add_f32 v[190:191], v[190:191], v[106:107]
    v_pk_mul_f32 v[188:189], v[188:189], v[122:123] op_sel_hi:[1,0]
    v_pk_mul_f32 v[190:191], v[190:191], v[122:123] op_sel_hi:[1,0]
    ds_read_b128 v[84:87], v9 offset:7168
    ds_read_b128 v[88:91], v9 offset:17408
    ds_read_b128 v[92:95], v9 offset:27648
    s_waitcnt lgkmcnt(9)
    v_pk_add_f32 v[192:193], v[192:193], v[108:109]
    v_pk_add_f32 v[194:195], v[194:195], v[110:111]
    v_pk_add_f32 v[192:193], v[192:193], v[112:113]
    v_pk_add_f32 v[194:195], v[194:195], v[114:115]
    v_pk_add_f32 v[192:193], v[192:193], v[116:117]
    v_pk_add_f32 v[194:195], v[194:195], v[118:119]
    v_pk_mul_f32 v[192:193], v[192:193], v[124:125] op_sel_hi:[1,0]
    v_pk_mul_f32 v[194:195], v[194:195], v[124:125] op_sel_hi:[1,0]
    ds_read_b128 v[96:99], v9 offset:8192
    ds_read_b128 v[100:103], v9 offset:18432
    ds_read_b128 v[104:107], v9 offset:28672
    s_waitcnt lgkmcnt(9)
    v_pk_add_f32 v[196:197], v[196:197], v[60:61]
    v_pk_add_f32 v[198:199], v[198:199], v[62:63]
    v_pk_add_f32 v[196:197], v[196:197], v[64:65]
    v_pk_add_f32 v[198:199], v[198:199], v[66:67]
    v_pk_add_f32 v[196:197], v[196:197], v[68:69]
    v_pk_add_f32 v[198:199], v[198:199], v[70:71]
    v_pk_mul_f32 v[196:197], v[196:197], v[124:125] op_sel_hi:[1,0]
    v_pk_mul_f32 v[198:199], v[198:199], v[124:125] op_sel_hi:[1,0]
    ds_read_b128 v[108:111], v9 offset:9216
    ds_read_b128 v[112:115], v9 offset:19456
    ds_read_b128 v[116:119], v9 offset:29696
    s_waitcnt lgkmcnt(9)
    v_pk_add_f32 v[200:201], v[200:201], v[72:73]
    v_pk_add_f32 v[202:203], v[202:203], v[74:75]
    v_pk_add_f32 v[200:201], v[200:201], v[76:77]
    v_pk_add_f32 v[202:203], v[202:203], v[78:79]
    v_pk_add_f32 v[200:201], v[200:201], v[80:81]
    v_pk_add_f32 v[202:203], v[202:203], v[82:83]
    v_pk_mul_f32 v[200:201], v[200:201], v[126:127] op_sel_hi:[1,0]
    v_pk_mul_f32 v[202:203], v[202:203], v[126:127] op_sel_hi:[1,0]
    s_waitcnt lgkmcnt(6)
    v_pk_add_f32 v[204:205], v[204:205], v[84:85]
    v_pk_add_f32 v[206:207], v[206:207], v[86:87]
    v_pk_add_f32 v[204:205], v[204:205], v[88:89]
    v_pk_add_f32 v[206:207], v[206:207], v[90:91]
    v_pk_add_f32 v[204:205], v[204:205], v[92:93]
    v_pk_add_f32 v[206:207], v[206:207], v[94:95]
    v_pk_mul_f32 v[204:205], v[204:205], v[126:127] op_sel_hi:[1,0]
    v_pk_mul_f32 v[206:207], v[206:207], v[126:127] op_sel_hi:[1,0]
    s_waitcnt lgkmcnt(3)
    v_pk_add_f32 v[208:209], v[208:209], v[96:97]
    v_pk_add_f32 v[210:211], v[210:211], v[98:99]
    v_pk_add_f32 v[208:209], v[208:209], v[100:101]
    v_pk_add_f32 v[210:211], v[210:211], v[102:103]
    v_pk_add_f32 v[208:209], v[208:209], v[104:105]
    v_pk_add_f32 v[210:211], v[210:211], v[106:107]
    v_pk_mul_f32 v[208:209], v[208:209], v[128:129] op_sel_hi:[1,0]
    v_pk_mul_f32 v[210:211], v[210:211], v[128:129] op_sel_hi:[1,0]
    s_waitcnt lgkmcnt(0)
    s_barrier
    v_pk_add_f32 v[212:213], v[212:213], v[108:109]
    v_pk_add_f32 v[214:215], v[214:215], v[110:111]
    v_pk_add_f32 v[212:213], v[212:213], v[112:113]
    v_pk_add_f32 v[214:215], v[214:215], v[114:115]
    v_pk_add_f32 v[212:213], v[212:213], v[116:117]
    v_pk_add_f32 v[214:215], v[214:215], v[118:119]
    v_pk_mul_f32 v[212:213], v[212:213], v[128:129] op_sel_hi:[1,0]
    v_pk_mul_f32 v[214:215], v[214:215], v[128:129] op_sel_hi:[1,0]
    s_cmp_eq_u64 s[90:91], 0
    s_cbranch_scc1 L_sum_ok
    s_cmp_eq_u32 s43, 0
    s_cbranch_scc1 L_fallback
L_sum_ok:
    v_cvt_pk_bf16_f32 v100, v176, v177
    v_cvt_pk_bf16_f32 v101, v178, v179
    v_cvt_pk_bf16_f32 v102, v180, v181
    v_cvt_pk_bf16_f32 v103, v182, v183
    v_cvt_pk_bf16_f32 v104, v184, v185
    v_cvt_pk_bf16_f32 v105, v186, v187
    v_cvt_pk_bf16_f32 v106, v188, v189
    v_cvt_pk_bf16_f32 v107, v190, v191
    v_cvt_pk_bf16_f32 v108, v192, v193
    v_cvt_pk_bf16_f32 v109, v194, v195
    v_cvt_pk_bf16_f32 v110, v196, v197
    v_cvt_pk_bf16_f32 v111, v198, v199
    v_cvt_pk_bf16_f32 v112, v200, v201
    v_cvt_pk_bf16_f32 v113, v202, v203
    v_cvt_pk_bf16_f32 v114, v204, v205
    v_cvt_pk_bf16_f32 v115, v206, v207
    v_cvt_pk_bf16_f32 v116, v208, v209
    v_cvt_pk_bf16_f32 v117, v210, v211
    v_cvt_pk_bf16_f32 v118, v212, v213
    v_cvt_pk_bf16_f32 v119, v214, v215
    s_lshl_b32 s30, s26, 2
    s_add_u32 s30, s30, s27
    s_mul_i32 s30, s30, 5120
    s_add_u32 s30, s30, s83
    buffer_store_dwordx4 v[100:103], v38, s[20:23], s30 offen offset:0 sc1
    buffer_store_dwordx4 v[104:107], v38, s[20:23], s30 offen offset:1024 sc1
    buffer_store_dwordx4 v[108:111], v38, s[20:23], s30 offen offset:2048 sc1
    buffer_store_dwordx4 v[112:115], v38, s[20:23], s30 offen offset:3072 sc1
    s_add_u32 s30, s30, 4096
    buffer_store_dwordx4 v[116:119], v38, s[20:23], s30 offen offset:0 sc1
    v_add_u32 v8, s39, v38
    ds_write_b128 v8, v[100:103] offset:0
    ds_write_b128 v8, v[104:107] offset:4096
    ds_write_b128 v8, v[108:111] offset:8192
    ds_write_b128 v8, v[112:115] offset:12288
    ds_write_b128 v8, v[116:119] offset:16384
    v_add_u32 v9, 0xffff0000, v245
    s_waitcnt vmcnt(0) lgkmcnt(0)
    s_barrier
    s_cmp_eq_u32 s27, 0
    s_cbranch_scc0 L_noflag1
    s_lshl_b32 s60, s26, 2
    s_add_u32 s60, s60, s81
    v_mov_b32 v2, 1
    s_mov_b64 exec, 1
    buffer_store_dword v2, off, s[52:55], s60 sc1
    s_mov_b64 exec, -1
L_noflag1:
    buffer_load_dwordx4 v[120:123], off, s[52:55], s81 sc1
    ds_read_b64_tr_b16 v[188:189], v246 offset:0
    ds_read_b64_tr_b16 v[190:191], v246 offset:4096
    ds_read_b128 v[204:207], v38 offset:0
    ds_read_b64_tr_b16 v[192:193], v246 offset:8
    ds_read_b64_tr_b16 v[194:195], v246 offset:4104
    ds_read_b128 v[208:211], v38 offset:4096
    ds_read_b128 v[212:215], v38 offset:8192
    ds_read_b128 v[216:219], v38 offset:12288
    ds_read_b128 v[220:223], v38 offset:16384
    s_waitcnt lgkmcnt(0)
    v_mfma_f32_16x16x32_bf16 v[148:151], v[188:191], v[204:207], 0
    ds_read_b64_tr_b16 v[196:197], v246 offset:8192
    ds_read_b64_tr_b16 v[198:199], v246 offset:12288
    v_mfma_f32_16x16x32_bf16 v[168:171], v[192:195], v[204:207], 0
    ds_read_b128 v[224:227], v38 offset:1024
    ds_read_b64_tr_b16 v[200:201], v246 offset:8200
    v_mfma_f32_16x16x32_bf16 v[152:155], v[188:191], v[208:211], 0
    ds_read_b64_tr_b16 v[202:203], v246 offset:12296
    ds_read_b128 v[228:231], v38 offset:5120
    v_mfma_f32_16x16x32_bf16 v[172:175], v[192:195], v[208:211], 0
    ds_read_b128 v[232:235], v38 offset:9216
    ds_read_b128 v[236:239], v38 offset:13312
    v_mfma_f32_16x16x32_bf16 v[156:159], v[188:191], v[212:215], 0
    ds_read_b128 v[240:243], v38 offset:17408
    s_lshl_b32 s60, s26, 1
    s_add_u32 s60, s60, 2
    s_and_b32 s60, s60, 7
    s_lshl_b32 s60, s60, 16
    s_add_u32 s41, s60, s88
    s_add_u32 m0, s39, 81920
    s_add_u32 s60, s41, 0
    buffer_load_dwordx4 v247, s[44:47], s60 offen lds
    v_mfma_f32_16x16x32_bf16 v[176:179], v[192:195], v[212:215], 0
    s_add_u32 m0, s39, 86016
    s_add_u32 s60, s41, 16384
    buffer_load_dwordx4 v247, s[44:47], s60 offen lds
    v_mfma_f32_16x16x32_bf16 v[160:163], v[188:191], v[216:219], 0
    s_add_u32 m0, s39, 90112
    s_add_u32 s60, s41, 32768
    buffer_load_dwordx4 v247, s[44:47], s60 offen lds
    v_mfma_f32_16x16x32_bf16 v[180:183], v[192:195], v[216:219], 0
    s_add_u32 m0, s39, 94208
    s_add_u32 s60, s41, 49152
    buffer_load_dwordx4 v247, s[44:47], s60 offen lds
    v_mfma_f32_16x16x32_bf16 v[164:167], v[188:191], v[220:223], 0
    v_mfma_f32_16x16x32_bf16 v[184:187], v[192:195], v[220:223], 0
    s_waitcnt lgkmcnt(0)
    s_barrier
    v_mfma_f32_16x16x32_bf16 v[148:151], v[196:199], v[224:227], v[148:151]
    ds_read_b64_tr_b16 v[188:189], v246 offset:16384
    ds_read_b64_tr_b16 v[190:191], v246 offset:20480
    v_mfma_f32_16x16x32_bf16 v[168:171], v[200:203], v[224:227], v[168:171]
    ds_read_b128 v[204:207], v38 offset:2048
    ds_read_b64_tr_b16 v[192:193], v246 offset:16392
    v_mfma_f32_16x16x32_bf16 v[152:155], v[196:199], v[228:231], v[152:155]
    ds_read_b64_tr_b16 v[194:195], v246 offset:20488
    ds_read_b128 v[208:211], v38 offset:6144
    v_mfma_f32_16x16x32_bf16 v[172:175], v[200:203], v[228:231], v[172:175]
    ds_read_b128 v[212:215], v38 offset:10240
    ds_read_b128 v[216:219], v38 offset:14336
    v_mfma_f32_16x16x32_bf16 v[156:159], v[196:199], v[232:235], v[156:159]
    ds_read_b128 v[220:223], v38 offset:18432
    s_lshl_b32 s60, s26, 1
    s_add_u32 s60, s60, 3
    s_and_b32 s60, s60, 7
    s_lshl_b32 s60, s60, 16
    s_add_u32 s41, s60, s88
    s_add_u32 m0, s39, 98304
    s_add_u32 s60, s41, 0
    buffer_load_dwordx4 v247, s[44:47], s60 offen lds
    v_mfma_f32_16x16x32_bf16 v[176:179], v[200:203], v[232:235], v[176:179]
    s_add_u32 m0, s39, 102400
    s_add_u32 s60, s41, 16384
    buffer_load_dwordx4 v247, s[44:47], s60 offen lds
    v_mfma_f32_16x16x32_bf16 v[160:163], v[196:199], v[236:239], v[160:163]
    s_add_u32 m0, s39, 106496
    s_add_u32 s60, s41, 32768
    buffer_load_dwordx4 v247, s[44:47], s60 offen lds
    v_mfma_f32_16x16x32_bf16 v[180:183], v[200:203], v[236:239], v[180:183]
    s_add_u32 m0, s39, 110592
    s_add_u32 s60, s41, 49152
    buffer_load_dwordx4 v247, s[44:47], s60 offen lds
    v_mfma_f32_16x16x32_bf16 v[164:167], v[196:199], v[240:243], v[164:167]
    v_mfma_f32_16x16x32_bf16 v[184:187], v[200:203], v[240:243], v[184:187]
    s_waitcnt lgkmcnt(0)
    v_mfma_f32_16x16x32_bf16 v[148:151], v[188:191], v[204:207], v[148:151]
    ds_read_b64_tr_b16 v[196:197], v246 offset:24576
    ds_read_b64_tr_b16 v[198:199], v246 offset:28672
    v_mfma_f32_16x16x32_bf16 v[168:171], v[192:195], v[204:207], v[168:171]
    ds_read_b128 v[224:227], v38 offset:3072
    ds_read_b64_tr_b16 v[200:201], v246 offset:24584
    v_mfma_f32_16x16x32_bf16 v[152:155], v[188:191], v[208:211], v[152:155]
    ds_read_b64_tr_b16 v[202:203], v246 offset:28680
    ds_read_b128 v[228:231], v38 offset:7168
    v_mfma_f32_16x16x32_bf16 v[172:175], v[192:195], v[208:211], v[172:175]
    ds_read_b128 v[232:235], v38 offset:11264
    ds_read_b128 v[236:239], v38 offset:15360
    v_mfma_f32_16x16x32_bf16 v[156:159], v[188:191], v[212:215], v[156:159]
    ds_read_b128 v[240:243], v38 offset:19456
    s_lshl_b32 s60, s26, 1
    s_add_u32 s60, s60, 4
    s_and_b32 s60, s60, 7
    s_lshl_b32 s60, s60, 16
    s_add_u32 s41, s60, s88
    s_add_u32 m0, s39, 114688
    s_add_u32 s60, s41, 0
    buffer_load_dwordx4 v247, s[44:47], s60 offen lds
    v_mfma_f32_16x16x32_bf16 v[176:179], v[192:195], v[212:215], v[176:179]
    s_add_u32 m0, s39, 118784
    s_add_u32 s60, s41, 16384
    buffer_load_dwordx4 v247, s[44:47], s60 offen lds
    v_mfma_f32_16x16x32_bf16 v[160:163], v[188:191], v[216:219], v[160:163]
    s_add_u32 m0, s39, 122880
    s_add_u32 s60, s41, 32768
    buffer_load_dwordx4 v247, s[44:47], s60 offen lds
    v_mfma_f32_16x16x32_bf16 v[180:183], v[192:195], v[216:219], v[180:183]
    s_add_u32 m0, s39, 126976
    s_add_u32 s60, s41, 49152
    buffer_load_dwordx4 v247, s[44:47], s60 offen lds
    v_mfma_f32_16x16x32_bf16 v[164:167], v[188:191], v[220:223], v[164:167]
    v_mfma_f32_16x16x32_bf16 v[184:187], v[192:195], v[220:223], v[184:187]
    s_waitcnt lgkmcnt(0)
    s_barrier
    v_mfma_f32_16x16x32_bf16 v[148:151], v[196:199], v[224:227], v[148:151]
    v_mfma_f32_16x16x32_bf16 v[168:171], v[200:203], v[224:227], v[168:171]
    v_mfma_f32_16x16x32_bf16 v[152:155], v[196:199], v[228:231], v[152:155]
    v_mfma_f32_16x16x32_bf16 v[172:175], v[200:203], v[228:231], v[172:175]
    v_mfma_f32_16x16x32_bf16 v[156:159], v[196:199], v[232:235], v[156:159]
    v_mfma_f32_16x16x32_bf16 v[176:179], v[200:203], v[232:235], v[176:179]
    v_mfma_f32_16x16x32_bf16 v[160:163], v[196:199], v[236:239], v[160:163]
    v_mfma_f32_16x16x32_bf16 v[180:183], v[200:203], v[236:239], v[180:183]
    v_mfma_f32_16x16x32_bf16 v[164:167], v[196:199], v[240:243], v[164:167]
    v_mfma_f32_16x16x32_bf16 v[184:187], v[200:203], v[240:243], v[184:187]
    v_min_u32 v248, v248, v249
    v_min_u32 v248, v248, v250
    v_min_u32 v248, v248, v251
    v_min_u32 v248, v248, v252
    v_min_u32 v248, v248, v253
    v_min_u32 v248, v248, v254
    v_min_u32 v248, v248, v255
    s_nop 0
    v_readfirstlane_b32 s60, v248
    s_nop 3
    s_cmp_ge_u32 s60, 4
    s_cselect_b32 s89, 1, 0
    s_cmp_ge_u32 s60, 4
    s_cbranch_scc1 L_done_init
    s_lshl_b32 s62, s25, 5
    s_mov_b32 s63, 20000
L_poll_init:
    buffer_load_dwordx4 v[248:251], off, s[56:59], s62 offset:0 sc1
    buffer_load_dwordx4 v[252:255], off, s[56:59], s62 offset:16 sc1
    s_waitcnt vmcnt(0)
    v_min_u32 v248, v248, v249
    v_min_u32 v248, v248, v250
    v_min_u32 v248, v248, v251
    v_min_u32 v248, v248, v252
    v_min_u32 v248, v248, v253
    v_min_u32 v248, v248, v254
    v_min_u32 v248, v248, v255
    s_nop 0
    v_readfirstlane_b32 s60, v248
    s_nop 3
    s_cmp_ge_u32 s60, 4
    s_cbranch_scc1 L_done_init
    s_sub_u32 s63, s63, 1
    s_cmp_eq_u32 s63, 0
    s_cbranch_scc1 L_done_init
    s_sleep 1
    s_branch L_poll_init
L_done_init:
    s_waitcnt vmcnt(0)
    s_cmp_eq_u32 s89, 1
    s_cbranch_scc0 L_look_again
    v_min_u32 v120, v120, v121
    v_min_u32 v120, v120, v122
    v_min_u32 v120, v120, v123
    s_nop 0
    v_readfirstlane_b32 s60, v120
    s_nop 3
    s_cmp_ge_u32 s60, 1
    s_cbranch_scc1 L_done_f1
L_look_again:
    s_mov_b32 s63, 20000
L_poll_f1:
    buffer_load_dwordx4 v[248:251], off, s[52:55], s81 offset:0 sc1
    s_waitcnt vmcnt(0)
    v_min_u32 v248, v248, v249
    v_min_u32 v248, v248, v250
    v_min_u32 v248, v248, v251
    s_nop 0
    v_readfirstlane_b32 s60, v248
    s_nop 3
    s_cmp_ge_u32 s60, 1
    s_cbranch_scc1 L_done_f1
    s_sub_u32 s63, s63, 1
    s_cmp_eq_u32 s63, 0
    s_cbranch_scc1 L_done_f1
    s_sleep 1
    s_branch L_poll_f1
L_done_f1:
    s_add_u32 s60, s26, 1
    s_and_b32 s60, s60, 3
    s_lshl_b32 s60, s60, 2
    s_add_u32 s60, s60, s27
    s_mul_i32 s60, s60, 5120
    s_add_u32 s40, s60, s83
    s_add_u32 m0, s39, 20480
    s_add_u32 s60, s40, 0
    buffer_load_dwordx4 v38, s[20:23], s60 offen sc1 lds
    s_add_u32 m0, s39, 24576
    s_add_u32 s60, s40, 1024
    buffer_load_dwordx4 v38, s[20:23], s60 offen sc1 lds
    s_add_u32 m0, s39, 28672
    s_add_u32 s60, s40, 2048
    buffer_load_dwordx4 v38, s[20:23], s60 offen sc1 lds
    s_add_u32 m0, s39, 32768
    s_add_u32 s60, s40, 3072
    buffer_load_dwordx4 v38, s[20:23], s60 offen sc1 lds
    s_add_u32 m0, s39, 36864
    s_add_u32 s60, s40, 4096
    buffer_load_dwordx4 v38, s[20:23], s60 offen sc1 lds
    s_add_u32 s60, s26, 2
    s_and_b32 s60, s60, 3
    s_lshl_b32 s60, s60, 2
    s_add_u32 s60, s60, s27
    s_mul_i32 s60, s60, 5120
    s_add_u32 s40, s60, s83
    s_add_u32 m0, s39, 40960
    s_add_u32 s60, s40, 0
    buffer_load_dwordx4 v38, s[20:23], s60 offen sc1 lds
    s_add_u32 m0, s39, 45056
    s_add_u32 s60, s40, 1024
    buffer_load_dwordx4 v38, s[20:23], s60 offen sc1 lds
    s_add_u32 m0, s39, 49152
    s_add_u32 s60, s40, 2048
    buffer_load_dwordx4 v38, s[20:23], s60 offen sc1 lds
    s_add_u32 m0, s39, 53248
    s_add_u32 s60, s40, 3072
    buffer_load_dwordx4 v38, s[20:23], s60 offen sc1 lds
    s_add_u32 m0, s39, 57344
    s_add_u32 s60, s40, 4096
    buffer_load_dwordx4 v38, s[20:23], s60 offen sc1 lds
    s_add_u32 s60, s26, 3
    s_and_b32 s60, s60, 3
    s_lshl_b32 s60, s60, 2
    s_add_u32 s60, s60, s27
    s_mul_i32 s60, s60, 5120
    s_add_u32 s40, s60, s83
    s_add_u32 m0, s39, 61440
    s_add_u32 s60, s40, 0
    buffer_load_dwordx4 v38, s[20:23], s60 offen sc1 lds
    s_add_u32 m0, s39, 65536
    s_add_u32 s60, s40, 1024
    buffer_load_dwordx4 v38, s[20:23], s60 offen sc1 lds
    s_add_u32 m0, s39, 69632
    s_add_u32 s60, s40, 2048
    buffer_load_dwordx4 v38, s[20:23], s60 offen sc1 lds
    s_add_u32 m0, s39, 73728
    s_add_u32 s60, s40, 3072
    buffer_load_dwordx4 v38, s[20:23], s60 offen sc1 lds
    s_add_u32 m0, s39, 77824
    s_add_u32 s60, s40, 4096
    buffer_load_dwordx4 v38, s[20:23], s60 offen sc1 lds
    s_waitcnt vmcnt(10)
    s_barrier
    ds_read_b64_tr_b16 v[188:189], v245 offset:16384
    ds_read_b64_tr_b16 v[190:191], v245 offset:20480
    ds_read_b128 v[204:207], v38 offset:20480
    ds_read_b64_tr_b16 v[192:193], v245 offset:16392
    ds_read_b64_tr_b16 v[194:195], v245 offset:20488
    ds_read_b128 v[208:211], v38 offset:24576
    ds_read_b128 v[212:215], v38 offset:28672
    ds_read_b128 v[216:219], v38 offset:32768
    ds_read_b128 v[220:223], v38 offset:36864
    s_waitcnt lgkmcnt(0)
    v_mfma_f32_16x16x32_bf16 v[148:151], v[188:191], v[204:207], v[148:151]
    ds_read_b64_tr_b16 v[196:197], v245 offset:24576
    ds_read_b64_tr_b16 v[198:199], v245 offset:28672
    v_mfma_f32_16x16x32_bf16 v[168:171], v[192:195], v[204:207], v[168:171]
    ds_read_b128 v[224:227], v38 offset:21504
    ds_read_b64_tr_b16 v[200:201], v245 offset:24584
    v_mfma_f32_16x16x32_bf16 v[152:155], v[188:191], v[208:211], v[152:155]
    ds_read_b64_tr_b16 v[202:203], v245 offset:28680
    ds_read_b128 v[228:231], v38 offset:25600
    v_mfma_f32_16x16x32_bf16 v[172:175], v[192:195], v[208:211], v[172:175]
    ds_read_b128 v[232:235], v38 offset:29696
    ds_read_b128 v[236:239], v38 offset:33792
    v_mfma_f32_16x16x32_bf16 v[156:159], v[188:191], v[212:215], v[156:159]
    ds_read_b128 v[240:243], v38 offset:37888
    s_lshl_b32 s60, s26, 1
    s_add_u32 s60, s60, 5
    s_and_b32 s60, s60, 7
    s_lshl_b32 s60, s60, 16
    s_add_u32 s41, s60, s88
    s_add_u32 m0, s39, 131072
    s_add_u32 s60, s41, 0
    buffer_load_dwordx4 v247, s[44:47], s60 offen lds
    v_mfma_f32_16x16x32_bf16 v[176:179], v[192:195], v[212:215], v[176:179]
    s_add_u32 m0, s39, 135168
    s_add_u32 s60, s41, 16384
    buffer_load_dwordx4 v247, s[44:47], s60 offen lds
    v_mfma_f32_16x16x32_bf16 v[160:163], v[188:191], v[216:219], v[160:163]
    s_add_u32 m0, s39, 139264
    s_add_u32 s60, s41, 32768
    buffer_load_dwordx4 v247, s[44:47], s60 offen lds
    v_mfma_f32_16x16x32_bf16 v[180:183], v[192:195], v[216:219], v[180:183]
    s_add_u32 m0, s39, 143360
    s_add_u32 s60, s41, 49152
    buffer_load_dwordx4 v247, s[44:47], s60 offen lds
    v_mfma_f32_16x16x32_bf16 v[164:167], v[188:191], v[220:223], v[164:167]
    v_mfma_f32_16x16x32_bf16 v[184:187], v[192:195], v[220:223], v[184:187]
    s_waitcnt lgkmcnt(0)
    v_mfma_f32_16x16x32_bf16 v[148:151], v[196:199], v[224:227], v[148:151]
    ds_read_b64_tr_b16 v[188:189], v245 offset:32768
    ds_read_b64_tr_b16 v[190:191], v245 offset:36864
    v_mfma_f32_16x16x32_bf16 v[168:171], v[200:203], v[224:227], v[168:171]
    ds_read_b128 v[204:207], v38 offset:22528
    ds_read_b64_tr_b16 v[192:193], v245 offset:32776
    v_mfma_f32_16x16x32_bf16 v[152:155], v[196:199], v[228:231], v[152:155]
    ds_read_b64_tr_b16 v[194:195], v245 offset:36872
    ds_read_b128 v[208:211], v38 offset:26624
    v_mfma_f32_16x16x32_bf16 v[172:175], v[200:203], v[228:231], v[172:175]
    ds_read_b128 v[212:215], v38 offset:30720
    ds_read_b128 v[216:219], v38 offset:34816
    v_mfma_f32_16x16x32_bf16 v[156:159], v[196:199], v[232:235], v[156:159]
    ds_read_b128 v[220:223], v38 offset:38912
    s_lshl_b32 s60, s26, 1
    s_add_u32 s60, s60, 6
    s_and_b32 s60, s60, 7
    s_lshl_b32 s60, s60, 16
    s_add_u32 s41, s60, s88
    s_add_u32 m0, s39, 147456
    s_add_u32 s60, s41, 0
    buffer_load_dwordx4 v247, s[44:47], s60 offen lds
    v_mfma_f32_16x16x32_bf16 v[176:179], v[200:203], v[232:235], v[176:179]
    s_add_u32 m0, s39, 151552
    s_add_u32 s60, s41, 16384
    buffer_load_dwordx4 v247, s[44:47], s60 offen lds
    v_mfma_f32_16x16x32_bf16 v[160:163], v[196:199], v[236:239], v[160:163]
    s_add_u32 m0, s39, 155648
    s_add_u32 s60, s41, 32768
    buffer_load_dwordx4 v247, s[44:47], s60 offen lds
    v_mfma_f32_16x16x32_bf16 v[180:183], v[200:203], v[236:239], v[180:183]
    s_add_u32 m0, s39, 159744
    s_add_u32 s60, s41, 49152
    buffer_load_dwordx4 v247, s[44:47], s60 offen lds
    v_mfma_f32_16x16x32_bf16 v[164:167], v[196:199], v[240:243], v[164:167]
    v_mfma_f32_16x16x32_bf16 v[184:187], v[200:203], v[240:243], v[184:187]
    s_waitcnt lgkmcnt(0)
    v_mfma_f32_16x16x32_bf16 v[148:151], v[188:191], v[204:207], v[148:151]
    ds_read_b64_tr_b16 v[196:197], v245 offset:40960
    ds_read_b64_tr_b16 v[198:199], v245 offset:45056
    v_mfma_f32_16x16x32_bf16 v[168:171], v[192:195], v[204:207], v[168:171]
    ds_read_b128 v[224:227], v38 offset:23552
    ds_read_b64_tr_b16 v[200:201], v245 offset:40968
    v_mfma_f32_16x16x32_bf16 v[152:155], v[188:191], v[208:211], v[152:155]
    ds_read_b64_tr_b16 v[202:203], v245 offset:45064
    ds_read_b128 v[228:231], v38 offset:27648
    v_mfma_f32_16x16x32_bf16 v[172:175], v[192:195], v[208:211], v[172:175]
    ds_read_b128 v[232:235], v38 offset:31744
    ds_read_b128 v[236:239], v38 offset:35840
    v_mfma_f32_16x16x32_bf16 v[156:159], v[188:191], v[212:215], v[156:159]
    ds_read_b128 v[240:243], v38 offset:39936
    s_lshl_b32 s60, s26, 1
    s_add_u32 s60, s60, 7
    s_and_b32 s60, s60, 7
    s_lshl_b32 s60, s60, 16
    s_add_u32 s41, s60, s88
    s_add_u32 m0, s39, 0
    s_add_u32 s60, s41, 0
    buffer_load_dwordx4 v247, s[44:47], s60 offen lds
    v_mfma_f32_16x16x32_bf16 v[176:179], v[192:195], v[212:215], v[176:179]
    s_add_u32 m0, s39, 4096
    s_add_u32 s60, s41, 16384
    buffer_load_dwordx4 v247, s[44:47], s60 offen lds
    v_mfma_f32_16x16x32_bf16 v[160:163], v[188:191], v[216:219], v[160:163]
    s_add_u32 m0, s39, 8192
    s_add_u32 s60, s41, 32768
    buffer_load_dwordx4 v247, s[44:47], s60 offen lds
    v_mfma_f32_16x16x32_bf16 v[180:183], v[192:195], v[216:219], v[180:183]
    s_add_u32 m0, s39, 12288
    s_add_u32 s60, s41, 49152
    buffer_load_dwordx4 v247, s[44:47], s60 offen lds
    v_mfma_f32_16x16x32_bf16 v[164:167], v[188:191], v[220:223], v[164:167]
    v_mfma_f32_16x16x32_bf16 v[184:187], v[192:195], v[220:223], v[184:187]
    s_waitcnt lgkmcnt(0)
    s_waitcnt vmcnt(17)
    s_barrier
    v_mfma_f32_16x16x32_bf16 v[148:151], v[196:199], v[224:227], v[148:151]
    ds_read_b64_tr_b16 v[188:189], v245 offset:49152
    ds_read_b64_tr_b16 v[190:191], v245 offset:53248
    v_mfma_f32_16x16x32_bf16 v[168:171], v[200:203], v[224:227], v[168:171]
    ds_read_b128 v[204:207], v38 offset:40960
    ds_read_b64_tr_b16 v[192:193], v245 offset:49160
    v_mfma_f32_16x16x32_bf16 v[152:155], v[196:199], v[228:231], v[152:155]
    ds_read_b64_tr_b16 v[194:195], v245 offset:53256
    ds_read_b128 v[208:211], v38 offset:45056
    v_mfma_f32_16x16x32_bf16 v[172:175], v[200:203], v[228:231], v[172:175]
    ds_read_b128 v[212:215], v38 offset:49152
    ds_read_b128 v[216:219], v38 offset:53248
    v_mfma_f32_16x16x32_bf16 v[156:159], v[196:199], v[232:235], v[156:159]
    ds_read_b128 v[220:223], v38 offset:57344
    v_mfma_f32_16x16x32_bf16 v[176:179], v[200:203], v[232:235], v[176:179]
    v_mfma_f32_16x16x32_bf16 v[160:163], v[196:199], v[236:239], v[160:163]
    v_mfma_f32_16x16x32_bf16 v[180:183], v[200:203], v[236:239], v[180:183]
    v_mfma_f32_16x16x32_bf16 v[164:167], v[196:199], v[240:243], v[164:167]
    v_mfma_f32_16x16x32_bf16 v[184:187], v[200:203], v[240:243], v[184:187]
    s_waitcnt lgkmcnt(0)
    v_mfma_f32_16x16x32_bf16 v[148:151], v[188:191], v[204:207], v[148:151]
    ds_read_b64_tr_b16 v[196:197], v245 offset:57344
    ds_read_b64_tr_b16 v[198:199], v245 offset:61440
    v_mfma_f32_16x16x32_bf16 v[168:171], v[192:195], v[204:207], v[168:171]
    ds_read_b128 v[224:227], v38 offset:41984
    ds_read_b64_tr_b16 v[200:201], v245 offset:57352
    v_mfma_f32_16x16x32_bf16 v[152:155], v[188:191], v[208:211], v[152:155]
    ds_read_b64_tr_b16 v[202:203], v245 offset:61448
    ds_read_b128 v[228:231], v38 offset:46080
    v_mfma_f32_16x16x32_bf16 v[172:175], v[192:195], v[208:211], v[172:175]
    ds_read_b128 v[232:235], v38 offset:50176
    ds_read_b128 v[236:239], v38 offset:54272
    v_mfma_f32_16x16x32_bf16 v[156:159], v[188:191], v[212:215], v[156:159]
    ds_read_b128 v[240:243], v38 offset:58368
    v_mfma_f32_16x16x32_bf16 v[176:179], v[192:195], v[212:215], v[176:179]
    v_mfma_f32_16x16x32_bf16 v[160:163], v[188:191], v[216:219], v[160:163]
    v_mfma_f32_16x16x32_bf16 v[180:183], v[192:195], v[216:219], v[180:183]
    v_mfma_f32_16x16x32_bf16 v[164:167], v[188:191], v[220:223], v[164:167]
    v_mfma_f32_16x16x32_bf16 v[184:187], v[192:195], v[220:223], v[184:187]
    s_waitcnt lgkmcnt(0)
    s_waitcnt vmcnt(8)
    s_barrier
    v_mfma_f32_16x16x32_bf16 v[148:151], v[196:199], v[224:227], v[148:151]
    ds_read_b64_tr_b16 v[188:189], v246 offset:0
    ds_read_b64_tr_b16 v[190:191], v246 offset:4096
    v_mfma_f32_16x16x32_bf16 v[168:171], v[200:203], v[224:227], v[168:171]
    ds_read_b128 v[204:207], v38 offset:43008
    ds_read_b64_tr_b16 v[192:193], v246 offset:8
    v_mfma_f32_16x16x32_bf16 v[152:155], v[196:199], v[228:231], v[152:155]
    ds_read_b64_tr_b16 v[194:195], v246 offset:4104
    ds_read_b128 v[208:211], v38 offset:47104
    v_mfma_f32_16x16x32_bf16 v[172:175], v[200:203], v[228:231], v[172:175]
    ds_read_b128 v[212:215], v38 offset:51200
    ds_read_b128 v[216:219], v38 offset:55296
    v_mfma_f32_16x16x32_bf16 v[156:159], v[196:199], v[232:235], v[156:159]
    ds_read_b128 v[220:223], v38 offset:59392
    v_mfma_f32_16x16x32_bf16 v[176:179], v[200:203], v[232:235], v[176:179]
    v_mfma_f32_16x16x32_bf16 v[160:163], v[196:199], v[236:239], v[160:163]
    v_mfma_f32_16x16x32_bf16 v[180:183], v[200:203], v[236:239], v[180:183]
    v_mfma_f32_16x16x32_bf16 v[164:167], v[196:199], v[240:243], v[164:167]
    v_mfma_f32_16x16x32_bf16 v[184:187], v[200:203], v[240:243], v[184:187]
    s_waitcnt lgkmcnt(0)
    v_mfma_f32_16x16x32_bf16 v[148:151], v[188:191], v[204:207], v[148:151]
    ds_read_b64_tr_b16 v[196:197], v246 offset:8192
    ds_read_b64_tr_b16 v[198:199], v246 offset:12288
    v_mfma_f32_16x16x32_bf16 v[168:171], v[192:195], v[204:207], v[168:171]
    ds_read_b128 v[224:227], v38 offset:44032
    ds_read_b64_tr_b16 v[200:201], v246 offset:8200
    v_mfma_f32_16x16x32_bf16 v[152:155], v[188:191], v[208:211], v[152:155]
    ds_read_b64_tr_b16 v[202:203], v246 offset:12296
    ds_read_b128 v[228:231], v38 offset:48128
    v_mfma_f32_16x16x32_bf16 v[172:175], v[192:195], v[208:211], v[172:175]
    ds_read_b128 v[232:235], v38 offset:52224
    ds_read_b128 v[236:239], v38 offset:56320
    v_mfma_f32_16x16x32_bf16 v[156:159], v[188:191], v[212:215], v[156:159]
    ds_read_b128 v[240:243], v38 offset:60416
    v_mfma_f32_16x16x32_bf16 v[176:179], v[192:195], v[212:215], v[176:179]
    v_mfma_f32_16x16x32_bf16 v[160:163], v[188:191], v[216:219], v[160:163]
    v_mfma_f32_16x16x32_bf16 v[180:183], v[192:195], v[216:219], v[180:183]
    v_mfma_f32_16x16x32_bf16 v[164:167], v[188:191], v[220:223], v[164:167]
    v_mfma_f32_16x16x32_bf16 v[184:187], v[192:195], v[220:223], v[184:187]
    s_waitcnt lgkmcnt(0)
    s_waitcnt vmcnt(4)
    s_barrier
    v_mfma_f32_16x16x32_bf16 v[148:151], v[196:199], v[224:227], v[148:151]
    ds_read_b64_tr_b16 v[188:189], v246 offset:16384
    ds_read_b64_tr_b16 v[190:191], v246 offset:20480
    v_mfma_f32_16x16x32_bf16 v[168:171], v[200:203], v[224:227], v[168:171]
    ds_read_b128 v[204:207], v38 offset:61440
    ds_read_b64_tr_b16 v[192:193], v246 offset:16392
    v_mfma_f32_16x16x32_bf16 v[152:155], v[196:199], v[228:231], v[152:155]
    ds_read_b64_tr_b16 v[194:195], v246 offset:20488
    ds_read_b128 v[208:211], v244 offset:0
    v_mfma_f32_16x16x32_bf16 v[172:175], v[200:203], v[228:231], v[172:175]
    ds_read_b128 v[212:215], v244 offset:4096
    ds_read_b128 v[216:219], v244 offset:8192
    v_mfma_f32_16x16x32_bf16 v[156:159], v[196:199], v[232:235], v[156:159]
    ds_read_b128 v[220:223], v244 offset:12288
    v_mfma_f32_16x16x32_bf16 v[176:179], v[200:203], v[232:235], v[176:179]
    v_mfma_f32_16x16x32_bf16 v[160:163], v[196:199], v[236:239], v[160:163]
    v_mfma_f32_16x16x32_bf16 v[180:183], v[200:203], v[236:239], v[180:183]
    v_mfma_f32_16x16x32_bf16 v[164:167], v[196:199], v[240:243], v[164:167]
    v_mfma_f32_16x16x32_bf16 v[184:187], v[200:203], v[240:243], v[184:187]
    s_waitcnt lgkmcnt(0)
    v_mfma_f32_16x16x32_bf16 v[148:151], v[188:191], v[204:207], v[148:151]
    ds_read_b64_tr_b16 v[196:197], v246 offset:24576
    ds_read_b64_tr_b16 v[198:199], v246 offset:28672
    v_mfma_f32_16x16x32_bf16 v[168:171], v[192:195], v[204:207], v[168:171]
    ds_read_b128 v[224:227], v38 offset:62464
    ds_read_b64_tr_b16 v[200:201], v246 offset:24584
    v_mfma_f32_16x16x32_bf16 v[152:155], v[188:191], v[208:211], v[152:155]
    ds_read_b64_tr_b16 v[202:203], v246 offset:28680
    ds_read_b128 v[228:231], v244 offset:1024
    v_mfma_f32_16x16x32_bf16 v[172:175], v[192:195], v[208:211], v[172:175]
    ds_read_b128 v[232:235], v244 offset:5120
    ds_read_b128 v[236:239], v244 offset:9216
    v_mfma_f32_16x16x32_bf16 v[156:159], v[188:191], v[212:215], v[156:159]
    ds_read_b128 v[240:243], v244 offset:13312
    v_mfma_f32_16x16x32_bf16 v[176:179], v[192:195], v[212:215], v[176:179]
    v_mfma_f32_16x16x32_bf16 v[160:163], v[188:191], v[216:219], v[160:163]
    v_mfma_f32_16x16x32_bf16 v[180:183], v[192:195], v[216:219], v[180:183]
    v_mfma_f32_16x16x32_bf16 v[164:167], v[188:191], v[220:223], v[164:167]
    v_mfma_f32_16x16x32_bf16 v[184:187], v[192:195], v[220:223], v[184:187]
    s_waitcnt lgkmcnt(0)
    s_waitcnt vmcnt(0)
    s_barrier
    v_mfma_f32_16x16x32_bf16 v[148:151], v[196:199], v[224:227], v[148:151]
    ds_read_b64_tr_b16 v[188:189], v9 offset:0
    ds_read_b64_tr_b16 v[190:191], v9 offset:4096
    v_mfma_f32_16x16x32_bf16 v[168:171], v[200:203], v[224:227], v[168:171]
    ds_read_b128 v[204:207], v38 offset:63488
    ds_read_b64_tr_b16 v[192:193], v9 offset:8
    v_mfma_f32_16x16x32_bf16 v[152:155], v[196:199], v[228:231], v[152:155]
    ds_read_b64_tr_b16 v[194:195], v9 offset:4104
    ds_read_b128 v[208:211], v244 offset:2048
    v_mfma_f32_16x16x32_bf16 v[172:175], v[200:203], v[228:231], v[172:175]
    ds_read_b128 v[212:215], v244 offset:6144
    ds_read_b128 v[216:219], v244 offset:10240
    v_mfma_f32_16x16x32_bf16 v[156:159], v[196:199], v[232:235], v[156:159]
    ds_read_b128 v[220:223], v244 offset:14336
    v_mfma_f32_16x16x32_bf16 v[176:179], v[200:203], v[232:235], v[176:179]
    v_mfma_f32_16x16x32_bf16 v[160:163], v[196:199], v[236:239], v[160:163]
    v_mfma_f32_16x16x32_bf16 v[180:183], v[200:203], v[236:239], v[180:183]
    v_mfma_f32_16x16x32_bf16 v[164:167], v[196:199], v[240:243], v[164:167]
    v_mfma_f32_16x16x32_bf16 v[184:187], v[200:203], v[240:243], v[184:187]
    s_waitcnt lgkmcnt(0)
    v_mfma_f32_16x16x32_bf16 v[148:151], v[188:191], v[204:207], v[148:151]
    ds_read_b64_tr_b16 v[196:197], v9 offset:8192
    ds_read_b64_tr_b16 v[198:199], v9 offset:12288
    v_mfma_f32_16x16x32_bf16 v[168:171], v[192:195], v[204:207], v[168:171]
    ds_read_b128 v[224:227], v38 offset:64512
    ds_read_b64_tr_b16 v[200:201], v9 offset:8200
    v_mfma_f32_16x16x32_bf16 v[152:155], v[188:191], v[208:211], v[152:155]
    ds_read_b64_tr_b16 v[202:203], v9 offset:12296
    ds_read_b128 v[228:231], v244 offset:3072
    v_mfma_f32_16x16x32_bf16 v[172:175], v[192:195], v[208:211], v[172:175]
    ds_read_b128 v[232:235], v244 offset:7168
    ds_read_b128 v[236:239], v244 offset:11264
    v_mfma_f32_16x16x32_bf16 v[156:159], v[188:191], v[212:215], v[156:159]
    ds_read_b128 v[240:243], v244 offset:15360
    v_mfma_f32_16x16x32_bf16 v[176:179], v[192:195], v[212:215], v[176:179]
    v_mfma_f32_16x16x32_bf16 v[160:163], v[188:191], v[216:219], v[160:163]
    v_mfma_f32_16x16x32_bf16 v[180:183], v[192:195], v[216:219], v[180:183]
    v_mfma_f32_16x16x32_bf16 v[164:167], v[188:191], v[220:223], v[164:167]
    v_mfma_f32_16x16x32_bf16 v[184:187], v[192:195], v[220:223], v[184:187]
    s_waitcnt lgkmcnt(0)
    v_mfma_f32_16x16x32_bf16 v[148:151], v[196:199], v[224:227], v[148:151]
    v_mfma_f32_16x16x32_bf16 v[168:171], v[200:203], v[224:227], v[168:171]
    v_mfma_f32_16x16x32_bf16 v[152:155], v[196:199], v[228:231], v[152:155]
    v_mfma_f32_16x16x32_bf16 v[172:175], v[200:203], v[228:231], v[172:175]
    v_mfma_f32_16x16x32_bf16 v[156:159], v[196:199], v[232:235], v[156:159]
    v_mfma_f32_16x16x32_bf16 v[176:179], v[200:203], v[232:235], v[176:179]
    v_mfma_f32_16x16x32_bf16 v[160:163], v[196:199], v[236:239], v[160:163]
    v_mfma_f32_16x16x32_bf16 v[180:183], v[200:203], v[236:239], v[180:183]
    v_mfma_f32_16x16x32_bf16 v[164:167], v[196:199], v[240:243], v[164:167]
    v_mfma_f32_16x16x32_bf16 v[184:187], v[200:203], v[240:243], v[184:187]
    s_lshl_b32 s30, s25, 2
    s_add_u32 s30, s30, s26
    s_lshl_b32 s30, s30, 2
    s_mul_i32 s83, s30, 40960
    s_mul_i32 s30, s27, 40960
    s_add_u32 s30, s30, s83
    s_lshl_b32 s31, s24, 10
    s_add_u32 s30, s30, s31
    v_cvt_pk_bf16_f32 v60, v148, v149
    v_cvt_pk_bf16_f32 v61, v150, v151
    v_cvt_pk_bf16_f32 v62, v168, v169
    v_cvt_pk_bf16_f32 v63, v170, v171
    s_add_u32 s31, s30, 0
    buffer_store_dwordx4 v[60:63], v38, s[48:51], s31 offen sc1
    v_cvt_pk_bf16_f32 v64, v152, v153
    v_cvt_pk_bf16_f32 v65, v154, v155
    v_cvt_pk_bf16_f32 v66, v172, v173
    v_cvt_pk_bf16_f32 v67, v174, v175
    s_add_u32 s31, s30, 8192
    buffer_store_dwordx4 v[64:67], v38, s[48:51], s31 offen sc1
    v_cvt_pk_bf16_f32 v68, v156, v157
    v_cvt_pk_bf16_f32 v69, v158, v159
    v_cvt_pk_bf16_f32 v70, v176, v177
    v_cvt_pk_bf16_f32 v71, v178, v179
    s_add_u32 s31, s30, 16384
    buffer_store_dwordx4 v[68:71], v38, s[48:51], s31 offen sc1
    v_cvt_pk_bf16_f32 v72, v160, v161
    v_cvt_pk_bf16_f32 v73, v162, v163
    v_cvt_pk_bf16_f32 v74, v180, v181
    v_cvt_pk_bf16_f32 v75, v182, v183
    s_add_u32 s31, s30, 24576
    buffer_store_dwordx4 v[72:75], v38, s[48:51], s31 offen sc1
    v_cvt_pk_bf16_f32 v76, v164, v165
    v_cvt_pk_bf16_f32 v77, v166, v167
    v_cvt_pk_bf16_f32 v78, v184, v185
    v_cvt_pk_bf16_f32 v79, v186, v187
    s_add_u32 s31, s30, 32768
    buffer_store_dwordx4 v[76:79], v38, s[48:51], s31 offen sc1
    s_waitcnt vmcnt(0)
    s_barrier
    s_cmp_eq_u32 s27, 0
    s_cbranch_scc0 L_noflag2
    s_lshl_b32 s60, s24, 2
    s_add_u32 s60, s60, s82
    v_mov_b32 v2, 1
    s_mov_b64 exec, 1
    buffer_store_dword v2, off, s[52:55], s60 sc1
    s_mov_b64 exec, -1
L_noflag2:
    s_lshl_b32 s30, s27, 3
    s_add_u32 s30, s30, s24
    s_cmp_ge_u32 s30, 20
    s_cbranch_scc1 L_fin
    s_mov_b32 s63, 20000
L_poll_f2:
    buffer_load_dwordx4 v[248:251], off, s[52:55], s82 offset:0 sc1
    buffer_load_dwordx4 v[252:255], off, s[52:55], s82 offset:16 sc1
    s_waitcnt vmcnt(0)
    v_min_u32 v248, v248, v249
    v_min_u32 v248, v248, v250
    v_min_u32 v248, v248, v251
    v_min_u32 v248, v248, v252
    v_min_u32 v248, v248, v253
    v_min_u32 v248, v248, v254
    v_min_u32 v248, v248, v255
    s_nop 0
    v_readfirstlane_b32 s60, v248
    s_nop 3
    s_cmp_ge_u32 s60, 1
    s_cbranch_scc1 L_done_f2
    s_sub_u32 s63, s63, 1
    s_cmp_eq_u32 s63, 0
    s_cbranch_scc1 L_done_f2
    s_sleep 1
    s_branch L_poll_f2
L_done_f2:
    s_mul_hi_u32 s31, s30, 858993460
    s_mul_i32 s60, s31, 5
    s_sub_u32 s61, s30, s60
    s_mul_i32 s60, s31, 40960
    s_add_u32 s60, s60, s83
    s_lshl_b32 s62, s61, 13
    s_add_u32 s60, s60, s62
    buffer_load_dwordx4 v[60:63], v38, s[48:51], s60 offen offset:0 sc1
    buffer_load_dwordx4 v[64:67], v38, s[48:51], s60 offen offset:1024 sc1
    buffer_load_dwordx4 v[68:71], v38, s[48:51], s60 offen offset:2048 sc1
    buffer_load_dwordx4 v[72:75], v38, s[48:51], s60 offen offset:3072 sc1
    s_add_u32 s60, s60, 4096
    buffer_load_dwordx4 v[76:79], v38, s[48:51], s60 offen offset:0 sc1
    buffer_load_dwordx4 v[80:83], v38, s[48:51], s60 offen offset:1024 sc1
    buffer_load_dwordx4 v[84:87], v38, s[48:51], s60 offen offset:2048 sc1
    buffer_load_dwordx4 v[88:91], v38, s[48:51], s60 offen offset:3072 sc1
    s_mul_i32 s60, s25, 80
    s_lshl_b32 s61, s61, 4
    s_add_u32 s60, s60, s61
    v_add_u32 v8, s60, v3
    v_lshlrev_b32 v8, 10, v8
    s_lshl_b32 s60, s26, 2
    s_add_u32 s60, s60, s31
    s_lshl_b32 s60, s60, 6
    v_lshl_add_u32 v8, v4, 4, v8
    v_add_u32 v8, s60, v8
    s_waitcnt vmcnt(7)
    v_lshlrev_b32 v100, 16, v60
    v_and_b32 v101, 0xffff0000, v60
    v_lshlrev_b32 v102, 16, v61
    v_and_b32 v103, 0xffff0000, v61
    v_lshlrev_b32 v104, 16, v62
    v_and_b32 v105, 0xffff0000, v62
    v_lshlrev_b32 v106, 16, v63
    v_and_b32 v107, 0xffff0000, v63
    s_waitcnt vmcnt(6)
    v_lshlrev_b32 v110, 16, v64
    v_and_b32 v111, 0xffff0000, v64
    v_lshlrev_b32 v112, 16, v65
    v_and_b32 v113, 0xffff0000, v65
    v_lshlrev_b32 v114, 16, v66
    v_and_b32 v115, 0xffff0000, v66
    v_lshlrev_b32 v116, 16, v67
    v_and_b32 v117, 0xffff0000, v67
    v_pk_add_f32 v[100:101], v[100:101], v[110:111]
    v_pk_add_f32 v[102:103], v[102:103], v[112:113]
    v_pk_add_f32 v[104:105], v[104:105], v[114:115]
    v_pk_add_f32 v[106:107], v[106:107], v[116:117]
    s_waitcnt vmcnt(5)
    v_lshlrev_b32 v110, 16, v68
    v_and_b32 v111, 0xffff0000, v68
    v_lshlrev_b32 v112, 16, v69
    v_and_b32 v113, 0xffff0000, v69
    v_lshlrev_b32 v114, 16, v70
    v_and_b32 v115, 0xffff0000, v70
    v_lshlrev_b32 v116, 16, v71
    v_and_b32 v117, 0xffff0000, v71
    v_pk_add_f32 v[100:101], v[100:101], v[110:111]
    v_pk_add_f32 v[102:103], v[102:103], v[112:113]
    v_pk_add_f32 v[104:105], v[104:105], v[114:115]
    v_pk_add_f32 v[106:107], v[106:107], v[116:117]
    s_waitcnt vmcnt(4)
    v_lshlrev_b32 v110, 16, v72
    v_and_b32 v111, 0xffff0000, v72
    v_lshlrev_b32 v112, 16, v73
    v_and_b32 v113, 0xffff0000, v73
    v_lshlrev_b32 v114, 16, v74
    v_and_b32 v115, 0xffff0000, v74
    v_lshlrev_b32 v116, 16, v75
    v_and_b32 v117, 0xffff0000, v75
    v_pk_add_f32 v[100:101], v[100:101], v[110:111]
    v_pk_add_f32 v[102:103], v[102:103], v[112:113]
    v_pk_add_f32 v[104:105], v[104:105], v[114:115]
    v_pk_add_f32 v[106:107], v[106:107], v[116:117]
    s_waitcnt vmcnt(3)
    v_lshlrev_b32 v110, 16, v76
    v_and_b32 v111, 0xffff0000, v76
    v_lshlrev_b32 v112, 16, v77
    v_and_b32 v113, 0xffff0000, v77
    v_lshlrev_b32 v114, 16, v78
    v_and_b32 v115, 0xffff0000, v78
    v_lshlrev_b32 v116, 16, v79
    v_and_b32 v117, 0xffff0000, v79
    v_pk_add_f32 v[100:101], v[100:101], v[110:111]
    v_pk_add_f32 v[102:103], v[102:103], v[112:113]
    v_pk_add_f32 v[104:105], v[104:105], v[114:115]
    v_pk_add_f32 v[106:107], v[106:107], v[116:117]
    s_waitcnt vmcnt(2)
    v_lshlrev_b32 v110, 16, v80
    v_and_b32 v111, 0xffff0000, v80
    v_lshlrev_b32 v112, 16, v81
    v_and_b32 v113, 0xffff0000, v81
    v_lshlrev_b32 v114, 16, v82
    v_and_b32 v115, 0xffff0000, v82
    v_lshlrev_b32 v116, 16, v83
    v_and_b32 v117, 0xffff0000, v83
    v_pk_add_f32 v[100:101], v[100:101], v[110:111]
    v_pk_add_f32 v[102:103], v[102:103], v[112:113]
    v_pk_add_f32 v[104:105], v[104:105], v[114:115]
    v_pk_add_f32 v[106:107], v[106:107], v[116:117]
    s_waitcnt vmcnt(1)
    v_lshlrev_b32 v110, 16, v84
    v_and_b32 v111, 0xffff0000, v84
    v_lshlrev_b32 v112, 16, v85
    v_and_b32 v113, 0xffff0000, v85
    v_lshlrev_b32 v114, 16, v86
    v_and_b32 v115, 0xffff0000, v86
    v_lshlrev_b32 v116, 16, v87
    v_and_b32 v117, 0xffff0000, v87
    v_pk_add_f32 v[100:101], v[100:101], v[110:111]
    v_pk_add_f32 v[102:103], v[102:103], v[112:113]
    v_pk_add_f32 v[104:105], v[104:105], v[114:115]
    v_pk_add_f32 v[106:107], v[106:107], v[116:117]
    s_waitcnt vmcnt(0)
    v_lshlrev_b32 v110, 16, v88
    v_and_b32 v111, 0xffff0000, v88
    v_lshlrev_b32 v112, 16, v89
    v_and_b32 v113, 0xffff0000, v89
    v_lshlrev_b32 v114, 16, v90
    v_and_b32 v115, 0xffff0000, v90
    v_lshlrev_b32 v116, 16, v91
    v_and_b32 v117, 0xffff0000, v91
    v_pk_add_f32 v[100:101], v[100:101], v[110:111]
    v_pk_add_f32 v[102:103], v[102:103], v[112:113]
    v_pk_add_f32 v[104:105], v[104:105], v[114:115]
    v_pk_add_f32 v[106:107], v[106:107], v[116:117]
    v_cvt_pk_bf16_f32 v124, v100, v101
    v_cvt_pk_bf16_f32 v125, v102, v103
    v_cvt_pk_bf16_f32 v126, v104, v105
    v_cvt_pk_bf16_f32 v127, v106, v107
    buffer_store_dwordx4 v[124:127], v8, s[84:87], 0 offen
L_fin:
    s_waitcnt vmcnt(0)
L_end:
    s_endpgm
L_side:
    s_add_u32 m0, s39, 131072
    s_add_u32 s60, s80, 0
    buffer_load_dwordx4 v38, s[44:47], s60 offen lds
    s_add_u32 m0, s39, 135168
    s_add_u32 s60, s80, 1024
    buffer_load_dwordx4 v38, s[44:47], s60 offen lds
    s_add_u32 m0, s39, 139264
    s_add_u32 s60, s80, 2048
    buffer_load_dwordx4 v38, s[44:47], s60 offen lds
    s_add_u32 m0, s39, 143360
    s_add_u32 s60, s80, 3072
    buffer_load_dwordx4 v38, s[44:47], s60 offen lds
    s_add_u32 m0, s29, 0
    s_branch L_side_back
L_text_main_end:
L_fallback:
    s_mov_b32 s43, 1
    v_accvgpr_write_b32 a0, 0
    v_accvgpr_write_b32 a1, 0
    v_accvgpr_write_b32 a2, 0
    v_accvgpr_write_b32 a3, 0
    v_accvgpr_write_b32 a4, 0
    v_accvgpr_write_b32 a5, 0
    v_accvgpr_write_b32 a6, 0
    v_accvgpr_write_b32 a7, 0
    v_accvgpr_write_b32 a8, 0
    v_accvgpr_write_b32 a9, 0
    v_accvgpr_write_b32 a10, 0
    v_accvgpr_write_b32 a11, 0
    v_accvgpr_write_b32 a12, 0
    v_accvgpr_write_b32 a13, 0
    v_accvgpr_write_b32 a14, 0
    v_accvgpr_write_b32 a15, 0
    v_accvgpr_write_b32 a16, 0
    v_accvgpr_write_b32 a17, 0
    v_accvgpr_write_b32 a18, 0
    v_accvgpr_write_b32 a19, 0
    v_accvgpr_write_b32 a20, 0
    v_accvgpr_write_b32 a21, 0
    v_accvgpr_write_b32 a22, 0
    v_accvgpr_write_b32 a23, 0
    v_accvgpr_write_b32 a24, 0
    v_accvgpr_write_b32 a25, 0
    v_accvgpr_write_b32 a26, 0
    v_accvgpr_write_b32 a27, 0
    v_accvgpr_write_b32 a28, 0
    v_accvgpr_write_b32 a29, 0
    v_accvgpr_write_b32 a30, 0
    v_accvgpr_write_b32 a31, 0
    v_accvgpr_write_b32 a32, 0
    v_accvgpr_write_b32 a33, 0
    v_accvgpr_write_b32 a34, 0
    v_accvgpr_write_b32 a35, 0
    v_accvgpr_write_b32 a36, 0
    v_accvgpr_write_b32 a37, 0
    v_accvgpr_write_b32 a38, 0
    v_accvgpr_write_b32 a39, 0
    v_accvgpr_write_b32 a40, 0
    v_accvgpr_write_b32 a41, 0
    v_accvgpr_write_b32 a42, 0
    v_accvgpr_write_b32 a43, 0
    v_accvgpr_write_b32 a44, 0
    v_accvgpr_write_b32 a45, 0
    v_accvgpr_write_b32 a46, 0
    v_accvgpr_write_b32 a47, 0
    v_accvgpr_write_b32 a48, 0
    v_accvgpr_write_b32 a49, 0
    v_accvgpr_write_b32 a50, 0
    v_accvgpr_write_b32 a51, 0
    v_accvgpr_write_b32 a52, 0
    v_accvgpr_write_b32 a53, 0
    v_accvgpr_write_b32 a54, 0
    v_accvgpr_write_b32 a55, 0
    v_accvgpr_write_b32 a56, 0
    v_accvgpr_write_b32 a57, 0
    v_accvgpr_write_b32 a58, 0
    v_accvgpr_write_b32 a59, 0
    v_accvgpr_write_b32 a60, 0
    v_accvgpr_write_b32 a61, 0
    v_accvgpr_write_b32 a62, 0
    v_accvgpr_write_b32 a63, 0
    v_accvgpr_write_b32 a64, 0
    v_accvgpr_write_b32 a65, 0
    v_accvgpr_write_b32 a66, 0
    v_accvgpr_write_b32 a67, 0
    v_accvgpr_write_b32 a68, 0
    v_accvgpr_write_b32 a69, 0
    v_accvgpr_write_b32 a70, 0
    v_accvgpr_write_b32 a71, 0
    v_accvgpr_write_b32 a72, 0
    v_accvgpr_write_b32 a73, 0
    v_accvgpr_write_b32 a74, 0
    v_accvgpr_write_b32 a75, 0
    v_accvgpr_write_b32 a76, 0
    v_accvgpr_write_b32 a77, 0
    v_accvgpr_write_b32 a78, 0
    v_accvgpr_write_b32 a79, 0
    v_accvgpr_write_b32 a80, 0
    v_accvgpr_write_b32 a81, 0
    v_accvgpr_write_b32 a82, 0
    v_accvgpr_write_b32 a83, 0
    v_accvgpr_write_b32 a84, 0
    v_accvgpr_write_b32 a85, 0
    v_accvgpr_write_b32 a86, 0
    v_accvgpr_write_b32 a87, 0
    v_accvgpr_write_b32 a88, 0
    v_accvgpr_write_b32 a89, 0
    v_accvgpr_write_b32 a90, 0
    v_accvgpr_write_b32 a91, 0
    v_accvgpr_write_b32 a92, 0
    v_accvgpr_write_b32 a93, 0
    v_accvgpr_write_b32 a94, 0
    v_accvgpr_write_b32 a95, 0
    v_accvgpr_write_b32 a96, 0
    v_accvgpr_write_b32 a97, 0
    v_accvgpr_write_b32 a98, 0
    v_accvgpr_write_b32 a99, 0
    v_accvgpr_write_b32 a100, 0
    v_accvgpr_write_b32 a101, 0
    v_accvgpr_write_b32 a102, 0
    v_accvgpr_write_b32 a103, 0
    v_accvgpr_write_b32 a104, 0
    v_accvgpr_write_b32 a105, 0
    v_accvgpr_write_b32 a106, 0
    v_accvgpr_write_b32 a107, 0
    v_accvgpr_write_b32 a108, 0
    v_accvgpr_write_b32 a109, 0
    v_accvgpr_write_b32 a110, 0
    v_accvgpr_write_b32 a111, 0
    v_accvgpr_write_b32 a112, 0
    v_accvgpr_write_b32 a113, 0
    v_accvgpr_write_b32 a114, 0
    v_accvgpr_write_b32 a115, 0
    v_accvgpr_write_b32 a116, 0
    v_accvgpr_write_b32 a117, 0
    v_accvgpr_write_b32 a118, 0
    v_accvgpr_write_b32 a119, 0
    v_accvgpr_write_b32 a120, 0
    v_accvgpr_write_b32 a121, 0
    v_accvgpr_write_b32 a122, 0
    v_accvgpr_write_b32 a123, 0
    v_accvgpr_write_b32 a124, 0
    v_accvgpr_write_b32 a125, 0
    v_accvgpr_write_b32 a126, 0
    v_accvgpr_write_b32 a127, 0
    v_accvgpr_write_b32 a128, 0
    v_accvgpr_write_b32 a129, 0
    v_accvgpr_write_b32 a130, 0
    v_accvgpr_write_b32 a131, 0
    v_accvgpr_write_b32 a132, 0
    v_accvgpr_write_b32 a133, 0
    v_accvgpr_write_b32 a134, 0
    v_accvgpr_write_b32 a135, 0
    v_accvgpr_write_b32 a136, 0
    v_accvgpr_write_b32 a137, 0
    v_accvgpr_write_b32 a138, 0
    v_accvgpr_write_b32 a139, 0
    v_accvgpr_write_b32 a140, 0
    v_accvgpr_write_b32 a141, 0
    v_accvgpr_write_b32 a142, 0
    v_accvgpr_write_b32 a143, 0
    v_accvgpr_write_b32 a144, 0
    v_accvgpr_write_b32 a145, 0
    v_accvgpr_write_b32 a146, 0
    v_accvgpr_write_b32 a147, 0
    v_accvgpr_write_b32 a148, 0
    v_accvgpr_write_b32 a149, 0
    v_accvgpr_write_b32 a150, 0
    v_accvgpr_write_b32 a151, 0
    v_accvgpr_write_b32 a152, 0
    v_accvgpr_write_b32 a153, 0
    v_accvgpr_write_b32 a154, 0
    v_accvgpr_write_b32 a155, 0
    v_accvgpr_write_b32 a156, 0
    v_accvgpr_write_b32 a157, 0
    v_accvgpr_write_b32 a158, 0
    v_accvgpr_write_b32 a159, 0
    v_mov_b32 v28, 0
    v_mov_b32 v29, 0
    v_mov_b32 v30, 0
    v_mov_b32 v31, 0
    v_mov_b32 v32, 0
    v_mov_b32 v33, 0
    v_mov_b32 v34, 0
    v_mov_b32 v35, 0
    v_mov_b32 v36, 0
    v_mov_b32 v37, 0
    v_mov_b32 v40, 0xff7fffff
    v_mov_b32 v41, 0xff7fffff
    v_mov_b32 v42, 0xff7fffff
    v_mov_b32 v43, 0xff7fffff
    v_mov_b32 v44, 0xff7fffff
    s_mov_b32 s38, 16
    s_mov_b32 s36, s34
L_fb_loop:
    s_add_u32 s37, s36, 4096
    s_add_u32 m0, s29, 0
    s_nop 0
    buffer_load_dwordx4 v22, s[8:11], s36 offen offset:0 lds
    buffer_load_dwordx4 v23, s[8:11], s36 offen offset:1024 lds
    buffer_load_dwordx4 v24, s[8:11], s36 offen offset:2048 lds
    buffer_load_dwordx4 v25, s[8:11], s36 offen offset:3072 lds
    s_add_u32 m0, s29, 4096
    s_nop 0
    buffer_load_dwordx4 v22, s[8:11], s37 offen offset:0 lds
    buffer_load_dwordx4 v23, s[8:11], s37 offen offset:1024 lds
    buffer_load_dwordx4 v24, s[8:11], s37 offen offset:2048 lds
    buffer_load_dwordx4 v25, s[8:11], s37 offen offset:3072 lds
    s_add_u32 m0, s29, 16384
    s_nop 0
    buffer_load_dwordx4 v26, s[12:15], s36 offen offset:0 lds
    buffer_load_dwordx4 v27, s[12:15], s36 offen offset:1024 lds
    buffer_load_dwordx4 v26, s[12:15], s36 offen offset:2048 lds
    buffer_load_dwordx4 v27, s[12:15], s36 offen offset:3072 lds
    s_add_u32 m0, s29, 20480
    s_nop 0
    buffer_load_dwordx4 v26, s[12:15], s37 offen offset:0 lds
    buffer_load_dwordx4 v27, s[12:15], s37 offen offset:1024 lds
    buffer_load_dwordx4 v26, s[12:15], s37 offen offset:2048 lds
    buffer_load_dwordx4 v27, s[12:15], s37 offen offset:3072 lds
    s_waitcnt vmcnt(0)
    ds_read_b128 v[84:87], v10 offset:0
    ds_read_b128 v[88:91], v11 offset:0
    ds_read_b128 v[92:95], v12 offset:0
    ds_read_b128 v[96:99], v13 offset:0
    ds_read_b128 v[100:103], v10 offset:4096
    ds_read_b128 v[104:107], v11 offset:4096
    ds_read_b128 v[108:111], v12 offset:4096
    ds_read_b128 v[112:115], v13 offset:4096
    ds_read_b64_tr_b16 v[116:117], v14 offset:16384
    ds_read_b64_tr_b16 v[118:119], v14 offset:20480
    ds_read_b64_tr_b16 v[120:121], v15 offset:16384
    ds_read_b64_tr_b16 v[122:123], v15 offset:20480
    ds_read_b64_tr_b16 v[124:125], v16 offset:16384
    ds_read_b64_tr_b16 v[126:127], v16 offset:20480
    ds_read_b64_tr_b16 v[128:129], v17 offset:16384
    ds_read_b64_tr_b16 v[130:131], v17 offset:20480
    ds_read_b64_tr_b16 v[132:133], v18 offset:16384
    ds_read_b64_tr_b16 v[134:135], v18 offset:20480
    ds_read_b64_tr_b16 v[136:137], v19 offset:16384
    ds_read_b64_tr_b16 v[138:139], v19 offset:20480
    ds_read_b64_tr_b16 v[140:141], v20 offset:16384
    ds_read_b64_tr_b16 v[142:143], v20 offset:20480
    ds_read_b64_tr_b16 v[144:145], v21 offset:16384
    ds_read_b64_tr_b16 v[146:147], v21 offset:20480
    s_waitcnt lgkmcnt(0)
    v_mfma_f32_16x16x32_bf16 v[160:163], v[84:87], a[160:163], 0
    v_mfma_f32_16x16x32_bf16 v[160:163], v[88:91], a[164:167], v[160:163]
    v_mfma_f32_16x16x32_bf16 v[160:163], v[92:95], a[168:171], v[160:163]
    v_mfma_f32_16x16x32_bf16 v[160:163], v[96:99], a[172:175], v[160:163]
    v_mfma_f32_16x16x32_bf16 v[164:167], v[100:103], a[160:163], 0
    v_mfma_f32_16x16x32_bf16 v[164:167], v[104:107], a[164:167], v[164:167]
    v_mfma_f32_16x16x32_bf16 v[164:167], v[108:111], a[168:171], v[164:167]
    v_mfma_f32_16x16x32_bf16 v[164:167], v[112:115], a[172:175], v[164:167]
    v_mfma_f32_16x16x32_bf16 v[168:171], v[84:87], a[176:179], 0
    v_mfma_f32_16x16x32_bf16 v[168:171], v[88:91], a[180:183], v[168:171]
    v_mfma_f32_16x16x32_bf16 v[168:171], v[92:95], a[184:187], v[168:171]
    v_mfma_f32_16x16x32_bf16 v[168:171], v[96:99], a[188:191], v[168:171]
    v_mfma_f32_16x16x32_bf16 v[172:175], v[100:103], a[176:179], 0
    v_mfma_f32_16x16x32_bf16 v[172:175], v[104:107], a[180:183], v[172:175]
    v_mfma_f32_16x16x32_bf16 v[172:175], v[108:111], a[184:187], v[172:175]
    v_mfma_f32_16x16x32_bf16 v[172:175], v[112:115], a[188:191], v[172:175]
    v_mfma_f32_16x16x32_bf16 v[176:179], v[84:87], a[192:195], 0
    v_mfma_f32_16x16x32_bf16 v[176:179], v[88:91], a[196:199], v[176:179]
    v_mfma_f32_16x16x32_bf16 v[176:179], v[92:95], a[200:203], v[176:179]
    v_mfma_f32_16x16x32_bf16 v[176:179], v[96:99], a[204:207], v[176:179]
    v_mfma_f32_16x16x32_bf16 v[180:183], v[100:103], a[192:195], 0
    v_mfma_f32_16x16x32_bf16 v[180:183], v[104:107], a[196:199], v[180:183]
    v_mfma_f32_16x16x32_bf16 v[180:183], v[108:111], a[200:203], v[180:183]
    v_mfma_f32_16x16x32_bf16 v[180:183], v[112:115], a[204:207], v[180:183]
    v_mfma_f32_16x16x32_bf16 v[184:187], v[84:87], a[208:211], 0
    v_mfma_f32_16x16x32_bf16 v[184:187], v[88:91], a[212:215], v[184:187]
    v_mfma_f32_16x16x32_bf16 v[184:187], v[92:95], a[216:219], v[184:187]
    v_mfma_f32_16x16x32_bf16 v[184:187], v[96:99], a[220:223], v[184:187]
    v_mfma_f32_16x16x32_bf16 v[188:191], v[100:103], a[208:211], 0
    v_mfma_f32_16x16x32_bf16 v[188:191], v[104:107], a[212:215], v[188:191]
    v_mfma_f32_16x16x32_bf16 v[188:191], v[108:111], a[216:219], v[188:191]
    v_mfma_f32_16x16x32_bf16 v[188:191], v[112:115], a[220:223], v[188:191]
    v_mfma_f32_16x16x32_bf16 v[192:195], v[84:87], a[224:227], 0
    v_mfma_f32_16x16x32_bf16 v[192:195], v[88:91], a[228:231], v[192:195]
    v_mfma_f32_16x16x32_bf16 v[192:195], v[92:95], a[232:235], v[192:195]
    v_mfma_f32_16x16x32_bf16 v[192:195], v[96:99], a[236:239], v[192:195]
    v_mfma_f32_16x16x32_bf16 v[196:199], v[100:103], a[224:227], 0
    v_mfma_f32_16x16x32_bf16 v[196:199], v[104:107], a[228:231], v[196:199]
    v_mfma_f32_16x16x32_bf16 v[196:199], v[108:111], a[232:235], v[196:199]
    v_mfma_f32_16x16x32_bf16 v[196:199], v[112:115], a[236:239], v[196:199]
    s_nop 7
    v_max3_f32 v148, v160, v161, v162
    v_max3_f32 v148, v148, v163, v164
    v_max3_f32 v148, v148, v165, v166
    v_max3_f32 v148, v148, v167, v40
    v_max3_f32 v149, v168, v169, v170
    v_max3_f32 v149, v149, v171, v172
    v_max3_f32 v149, v149, v173, v174
    v_max3_f32 v149, v149, v175, v41
    v_max3_f32 v150, v176, v177, v178
    v_max3_f32 v150, v150, v179, v180
    v_max3_f32 v150, v150, v181, v182
    v_max3_f32 v150, v150, v183, v42
    v_max3_f32 v151, v184, v185, v186
    v_max3_f32 v151, v151, v187, v188
    v_max3_f32 v151, v151, v189, v190
    v_max3_f32 v151, v151, v191, v43
    v_max3_f32 v152, v192, v193, v194
    v_max3_f32 v152, v152, v195, v196
    v_max3_f32 v152, v152, v197, v198
    v_max3_f32 v152, v152, v199, v44
    s_nop 1
    v_mov_b32 v153, v148
    v_mov_b32 v154, v149
    v_mov_b32 v155, v150
    v_mov_b32 v156, v151
    v_mov_b32 v157, v152
    v_permlane32_swap_b32 v148, v153
    v_permlane32_swap_b32 v149, v154
    v_permlane32_swap_b32 v150, v155
    v_permlane32_swap_b32 v151, v156
    v_permlane32_swap_b32 v152, v157
    v_max_f32 v148, v148, v153
    v_max_f32 v149, v149, v154
    v_max_f32 v150, v150, v155
    v_max_f32 v151, v151, v156
    v_max_f32 v152, v152, v157
    v_mov_b32 v153, v148
    v_mov_b32 v154, v149
    v_mov_b32 v155, v150
    v_mov_b32 v156, v151
    v_mov_b32 v157, v152
    v_permlane16_swap_b32 v148, v153
    v_permlane16_swap_b32 v149, v154
    v_permlane16_swap_b32 v150, v155
    v_permlane16_swap_b32 v151, v156
    v_permlane16_swap_b32 v152, v157
    v_max_f32 v148, v148, v153
    v_max_f32 v149, v149, v154
    v_max_f32 v150, v150, v155
    v_max_f32 v151, v151, v156
    v_max_f32 v152, v152, v157
    v_sub_f32 v48, v40, v148
    v_sub_f32 v49, v41, v149
    v_sub_f32 v50, v42, v150
    v_sub_f32 v51, v43, v151
    v_sub_f32 v52, v44, v152
    v_exp_f32 v48, v48
    v_exp_f32 v49, v49
    v_exp_f32 v50, v50
    v_exp_f32 v51, v51
    v_exp_f32 v52, v52
    v_mov_b32 v40, v148
    v_mov_b32 v41, v149
    v_mov_b32 v42, v150
    v_mov_b32 v43, v151
    v_mov_b32 v44, v152
    v_sub_f32 v160, v160, v40
    v_sub_f32 v161, v161, v40
    v_sub_f32 v162, v162, v40
    v_sub_f32 v163, v163, v40
    v_sub_f32 v164, v164, v40
    v_sub_f32 v165, v165, v40
    v_sub_f32 v166, v166, v40
    v_sub_f32 v167, v167, v40
    v_sub_f32 v168, v168, v41
    v_sub_f32 v169, v169, v41
    v_sub_f32 v170, v170, v41
    v_sub_f32 v171, v171, v41
    v_sub_f32 v172, v172, v41
    v_sub_f32 v173, v173, v41
    v_sub_f32 v174, v174, v41
    v_sub_f32 v175, v175, v41
    v_sub_f32 v176, v176, v42
    v_sub_f32 v177, v177, v42
    v_sub_f32 v178, v178, v42
    v_sub_f32 v179, v179, v42
    v_sub_f32 v180, v180, v42
    v_sub_f32 v181, v181, v42
    v_sub_f32 v182, v182, v42
    v_sub_f32 v183, v183, v42
    v_sub_f32 v184, v184, v43
    v_sub_f32 v185, v185, v43
    v_sub_f32 v186, v186, v43
    v_sub_f32 v187, v187, v43
    v_sub_f32 v188, v188, v43
    v_sub_f32 v189, v189, v43
    v_sub_f32 v190, v190, v43
    v_sub_f32 v191, v191, v43
    v_sub_f32 v192, v192, v44
    v_sub_f32 v193, v193, v44
    v_sub_f32 v194, v194, v44
    v_sub_f32 v195, v195, v44
    v_sub_f32 v196, v196, v44
    v_sub_f32 v197, v197, v44
    v_sub_f32 v198, v198, v44
    v_sub_f32 v199, v199, v44
    v_exp_f32 v160, v160
    v_exp_f32 v161, v161
    v_exp_f32 v162, v162
    v_exp_f32 v163, v163
    v_exp_f32 v164, v164
    v_exp_f32 v165, v165
    v_exp_f32 v166, v166
    v_exp_f32 v167, v167
    v_exp_f32 v168, v168
    v_exp_f32 v169, v169
    v_exp_f32 v170, v170
    v_exp_f32 v171, v171
    v_exp_f32 v172, v172
    v_exp_f32 v173, v173
    v_exp_f32 v174, v174
    v_exp_f32 v175, v175
    v_exp_f32 v176, v176
    v_exp_f32 v177, v177
    v_exp_f32 v178, v178
    v_exp_f32 v179, v179
    v_exp_f32 v180, v180
    v_exp_f32 v181, v181
    v_exp_f32 v182, v182
    v_exp_f32 v183, v183
    v_exp_f32 v184, v184
    v_exp_f32 v185, v185
    v_exp_f32 v186, v186
    v_exp_f32 v187, v187
    v_exp_f32 v188, v188
    v_exp_f32 v189, v189
    v_exp_f32 v190, v190
    v_exp_f32 v191, v191
    v_exp_f32 v192, v192
    v_exp_f32 v193, v193
    v_exp_f32 v194, v194
    v_exp_f32 v195, v195
    v_exp_f32 v196, v196
    v_exp_f32 v197, v197
    v_exp_f32 v198, v198
    v_exp_f32 v199, v199
    s_nop 0
    v_mul_f32 v28, v28, v48
    v_add_f32 v28, v28, v160
    v_add_f32 v28, v28, v161
    v_add_f32 v28, v28, v162
    v_add_f32 v28, v28, v163
    v_add_f32 v28, v28, v164
    v_add_f32 v28, v28, v165
    v_add_f32 v28, v28, v166
    v_add_f32 v28, v28, v167
    v_mul_f32 v30, v30, v49
    v_add_f32 v30, v30, v168
    v_add_f32 v30, v30, v169
    v_add_f32 v30, v30, v170
    v_add_f32 v30, v30, v171
    v_add_f32 v30, v30, v172
    v_add_f32 v30, v30, v173
    v_add_f32 v30, v30, v174
    v_add_f32 v30, v30, v175
    v_mul_f32 v32, v32, v50
    v_add_f32 v32, v32, v176
    v_add_f32 v32, v32, v177
    v_add_f32 v32, v32, v178
    v_add_f32 v32, v32, v179
    v_add_f32 v32, v32, v180
    v_add_f32 v32, v32, v181
    v_add_f32 v32, v32, v182
    v_add_f32 v32, v32, v183
    v_mul_f32 v34, v34, v51
    v_add_f32 v34, v34, v184
    v_add_f32 v34, v34, v185
    v_add_f32 v34, v34, v186
    v_add_f32 v34, v34, v187
    v_add_f32 v34, v34, v188
    v_add_f32 v34, v34, v189
    v_add_f32 v34, v34, v190
    v_add_f32 v34, v34, v191
    v_mul_f32 v36, v36, v52
    v_add_f32 v36, v36, v192
    v_add_f32 v36, v36, v193
    v_add_f32 v36, v36, v194
    v_add_f32 v36, v36, v195
    v_add_f32 v36, v36, v196
    v_add_f32 v36, v36, v197
    v_add_f32 v36, v36, v198
    v_add_f32 v36, v36, v199
    v_accvgpr_read_b32 v158, a0
    v_mul_f32 v158, v158, v48
    v_accvgpr_write_b32 a0, v158
    v_accvgpr_read_b32 v158, a1
    v_mul_f32 v158, v158, v48
    v_accvgpr_write_b32 a1, v158
    v_accvgpr_read_b32 v158, a2
    v_mul_f32 v158, v158, v48
    v_accvgpr_write_b32 a2, v158
    v_accvgpr_read_b32 v158, a3
    v_mul_f32 v158, v158, v48
    v_accvgpr_write_b32 a3, v158
    v_accvgpr_read_b32 v158, a4
    v_mul_f32 v158, v158, v48
    v_accvgpr_write_b32 a4, v158
    v_accvgpr_read_b32 v158, a5
    v_mul_f32 v158, v158, v48
    v_accvgpr_write_b32 a5, v158
    v_accvgpr_read_b32 v158, a6
    v_mul_f32 v158, v158, v48
    v_accvgpr_write_b32 a6, v158
    v_accvgpr_read_b32 v158, a7
    v_mul_f32 v158, v158, v48
    v_accvgpr_write_b32 a7, v158
    v_accvgpr_read_b32 v158, a8
    v_mul_f32 v158, v158, v48
    v_accvgpr_write_b32 a8, v158
    v_accvgpr_read_b32 v158, a9
    v_mul_f32 v158, v158, v48
    v_accvgpr_write_b32 a9, v158
    v_accvgpr_read_b32 v158, a10
    v_mul_f32 v158, v158, v48
    v_accvgpr_write_b32 a10, v158
    v_accvgpr_read_b32 v158, a11
    v_mul_f32 v158, v158, v48
    v_accvgpr_write_b32 a11, v158
    v_accvgpr_read_b32 v158, a12
    v_mul_f32 v158, v158, v48
    v_accvgpr_write_b32 a12, v158
    v_accvgpr_read_b32 v158, a13
    v_mul_f32 v158, v158, v48
    v_accvgpr_write_b32 a13, v158
    v_accvgpr_read_b32 v158, a14
    v_mul_f32 v158, v158, v48
    v_accvgpr_write_b32 a14, v158
    v_accvgpr_read_b32 v158, a15
    v_mul_f32 v158, v158, v48
    v_accvgpr_write_b32 a15, v158
    v_accvgpr_read_b32 v158, a16
    v_mul_f32 v158, v158, v48
    v_accvgpr_write_b32 a16, v158
    v_accvgpr_read_b32 v158, a17
    v_mul_f32 v158, v158, v48
    v_accvgpr_write_b32 a17, v158
    v_accvgpr_read_b32 v158, a18
    v_mul_f32 v158, v158, v48
    v_accvgpr_write_b32 a18, v158
    v_accvgpr_read_b32 v158, a19
    v_mul_f32 v158, v158, v48
    v_accvgpr_write_b32 a19, v158
    v_accvgpr_read_b32 v158, a20
    v_mul_f32 v158, v158, v48
    v_accvgpr_write_b32 a20, v158
    v_accvgpr_read_b32 v158, a21
    v_mul_f32 v158, v158, v48
    v_accvgpr_write_b32 a21, v158
    v_accvgpr_read_b32 v158, a22
    v_mul_f32 v158, v158, v48
    v_accvgpr_write_b32 a22, v158
    v_accvgpr_read_b32 v158, a23
    v_mul_f32 v158, v158, v48
    v_accvgpr_write_b32 a23, v158
    v_accvgpr_read_b32 v158, a24
    v_mul_f32 v158, v158, v48
    v_accvgpr_write_b32 a24, v158
    v_accvgpr_read_b32 v158, a25
    v_mul_f32 v158, v158, v48
    v_accvgpr_write_b32 a25, v158
    v_accvgpr_read_b32 v158, a26
    v_mul_f32 v158, v158, v48
    v_accvgpr_write_b32 a26, v158
    v_accvgpr_read_b32 v158, a27
    v_mul_f32 v158, v158, v48
    v_accvgpr_write_b32 a27, v158
    v_accvgpr_read_b32 v158, a28
    v_mul_f32 v158, v158, v48
    v_accvgpr_write_b32 a28, v158
    v_accvgpr_read_b32 v158, a29
    v_mul_f32 v158, v158, v48
    v_accvgpr_write_b32 a29, v158
    v_accvgpr_read_b32 v158, a30
    v_mul_f32 v158, v158, v48
    v_accvgpr_write_b32 a30, v158
    v_accvgpr_read_b32 v158, a31
    v_mul_f32 v158, v158, v48
    v_accvgpr_write_b32 a31, v158
    v_accvgpr_read_b32 v158, a32
    v_mul_f32 v158, v158, v49
    v_accvgpr_write_b32 a32, v158
    v_accvgpr_read_b32 v158, a33
    v_mul_f32 v158, v158, v49
    v_accvgpr_write_b32 a33, v158
    v_accvgpr_read_b32 v158, a34
    v_mul_f32 v158, v158, v49
    v_accvgpr_write_b32 a34, v158
    v_accvgpr_read_b32 v158, a35
    v_mul_f32 v158, v158, v49
    v_accvgpr_write_b32 a35, v158
    v_accvgpr_read_b32 v158, a36
    v_mul_f32 v158, v158, v49
    v_accvgpr_write_b32 a36, v158
    v_accvgpr_read_b32 v158, a37
    v_mul_f32 v158, v158, v49
    v_accvgpr_write_b32 a37, v158
    v_accvgpr_read_b32 v158, a38
    v_mul_f32 v158, v158, v49
    v_accvgpr_write_b32 a38, v158
    v_accvgpr_read_b32 v158, a39
    v_mul_f32 v158, v158, v49
    v_accvgpr_write_b32 a39, v158
    v_accvgpr_read_b32 v158, a40
    v_mul_f32 v158, v158, v49
    v_accvgpr_write_b32 a40, v158
    v_accvgpr_read_b32 v158, a41
    v_mul_f32 v158, v158, v49
    v_accvgpr_write_b32 a41, v158
    v_accvgpr_read_b32 v158, a42
    v_mul_f32 v158, v158, v49
    v_accvgpr_write_b32 a42, v158
    v_accvgpr_read_b32 v158, a43
    v_mul_f32 v158, v158, v49
    v_accvgpr_write_b32 a43, v158
    v_accvgpr_read_b32 v158, a44
    v_mul_f32 v158, v158, v49
    v_accvgpr_write_b32 a44, v158
    v_accvgpr_read_b32 v158, a45
    v_mul_f32 v158, v158, v49
    v_accvgpr_write_b32 a45, v158
    v_accvgpr_read_b32 v158, a46
    v_mul_f32 v158, v158, v49
    v_accvgpr_write_b32 a46, v158
    v_accvgpr_read_b32 v158, a47
    v_mul_f32 v158, v158, v49
    v_accvgpr_write_b32 a47, v158
    v_accvgpr_read_b32 v158, a48
    v_mul_f32 v158, v158, v49
    v_accvgpr_write_b32 a48, v158
    v_accvgpr_read_b32 v158, a49
    v_mul_f32 v158, v158, v49
    v_accvgpr_write_b32 a49, v158
    v_accvgpr_read_b32 v158, a50
    v_mul_f32 v158, v158, v49
    v_accvgpr_write_b32 a50, v158
    v_accvgpr_read_b32 v158, a51
    v_mul_f32 v158, v158, v49
    v_accvgpr_write_b32 a51, v158
    v_accvgpr_read_b32 v158, a52
    v_mul_f32 v158, v158, v49
    v_accvgpr_write_b32 a52, v158
    v_accvgpr_read_b32 v158, a53
    v_mul_f32 v158, v158, v49
    v_accvgpr_write_b32 a53, v158
    v_accvgpr_read_b32 v158, a54
    v_mul_f32 v158, v158, v49
    v_accvgpr_write_b32 a54, v158
    v_accvgpr_read_b32 v158, a55
    v_mul_f32 v158, v158, v49
    v_accvgpr_write_b32 a55, v158
    v_accvgpr_read_b32 v158, a56
    v_mul_f32 v158, v158, v49
    v_accvgpr_write_b32 a56, v158
    v_accvgpr_read_b32 v158, a57
    v_mul_f32 v158, v158, v49
    v_accvgpr_write_b32 a57, v158
    v_accvgpr_read_b32 v158, a58
    v_mul_f32 v158, v158, v49
    v_accvgpr_write_b32 a58, v158
    v_accvgpr_read_b32 v158, a59
    v_mul_f32 v158, v158, v49
    v_accvgpr_write_b32 a59, v158
    v_accvgpr_read_b32 v158, a60
    v_mul_f32 v158, v158, v49
    v_accvgpr_write_b32 a60, v158
    v_accvgpr_read_b32 v158, a61
    v_mul_f32 v158, v158, v49
    v_accvgpr_write_b32 a61, v158
    v_accvgpr_read_b32 v158, a62
    v_mul_f32 v158, v158, v49
    v_accvgpr_write_b32 a62, v158
    v_accvgpr_read_b32 v158, a63
    v_mul_f32 v158, v158, v49
    v_accvgpr_write_b32 a63, v158
    v_accvgpr_read_b32 v158, a64
    v_mul_f32 v158, v158, v50
    v_accvgpr_write_b32 a64, v158
    v_accvgpr_read_b32 v158, a65
    v_mul_f32 v158, v158, v50
    v_accvgpr_write_b32 a65, v158
    v_accvgpr_read_b32 v158, a66
    v_mul_f32 v158, v158, v50
    v_accvgpr_write_b32 a66, v158
    v_accvgpr_read_b32 v158, a67
    v_mul_f32 v158, v158, v50
    v_accvgpr_write_b32 a67, v158
    v_accvgpr_read_b32 v158, a68
    v_mul_f32 v158, v158, v50
    v_accvgpr_write_b32 a68, v158
    v_accvgpr_read_b32 v158, a69
    v_mul_f32 v158, v158, v50
    v_accvgpr_write_b32 a69, v158
    v_accvgpr_read_b32 v158, a70
    v_mul_f32 v158, v158, v50
    v_accvgpr_write_b32 a70, v158
    v_accvgpr_read_b32 v158, a71
    v_mul_f32 v158, v158, v50
    v_accvgpr_write_b32 a71, v158
    v_accvgpr_read_b32 v158, a72
    v_mul_f32 v158, v158, v50
    v_accvgpr_write_b32 a72, v158
    v_accvgpr_read_b32 v158, a73
    v_mul_f32 v158, v158, v50
    v_accvgpr_write_b32 a73, v158
    v_accvgpr_read_b32 v158, a74
    v_mul_f32 v158, v158, v50
    v_accvgpr_write_b32 a74, v158
    v_accvgpr_read_b32 v158, a75
    v_mul_f32 v158, v158, v50
    v_accvgpr_write_b32 a75, v158
    v_accvgpr_read_b32 v158, a76
    v_mul_f32 v158, v158, v50
    v_accvgpr_write_b32 a76, v158
    v_accvgpr_read_b32 v158, a77
    v_mul_f32 v158, v158, v50
    v_accvgpr_write_b32 a77, v158
    v_accvgpr_read_b32 v158, a78
    v_mul_f32 v158, v158, v50
    v_accvgpr_write_b32 a78, v158
    v_accvgpr_read_b32 v158, a79
    v_mul_f32 v158, v158, v50
    v_accvgpr_write_b32 a79, v158
    v_accvgpr_read_b32 v158, a80
    v_mul_f32 v158, v158, v50
    v_accvgpr_write_b32 a80, v158
    v_accvgpr_read_b32 v158, a81
    v_mul_f32 v158, v158, v50
    v_accvgpr_write_b32 a81, v158
    v_accvgpr_read_b32 v158, a82
    v_mul_f32 v158, v158, v50
    v_accvgpr_write_b32 a82, v158
    v_accvgpr_read_b32 v158, a83
    v_mul_f32 v158, v158, v50
    v_accvgpr_write_b32 a83, v158
    v_accvgpr_read_b32 v158, a84
    v_mul_f32 v158, v158, v50
    v_accvgpr_write_b32 a84, v158
    v_accvgpr_read_b32 v158, a85
    v_mul_f32 v158, v158, v50
    v_accvgpr_write_b32 a85, v158
    v_accvgpr_read_b32 v158, a86
    v_mul_f32 v158, v158, v50
    v_accvgpr_write_b32 a86, v158
    v_accvgpr_read_b32 v158, a87
    v_mul_f32 v158, v158, v50
    v_accvgpr_write_b32 a87, v158
    v_accvgpr_read_b32 v158, a88
    v_mul_f32 v158, v158, v50
    v_accvgpr_write_b32 a88, v158
    v_accvgpr_read_b32 v158, a89
    v_mul_f32 v158, v158, v50
    v_accvgpr_write_b32 a89, v158
    v_accvgpr_read_b32 v158, a90
    v_mul_f32 v158, v158, v50
    v_accvgpr_write_b32 a90, v158
    v_accvgpr_read_b32 v158, a91
    v_mul_f32 v158, v158, v50
    v_accvgpr_write_b32 a91, v158
    v_accvgpr_read_b32 v158, a92
    v_mul_f32 v158, v158, v50
    v_accvgpr_write_b32 a92, v158
    v_accvgpr_read_b32 v158, a93
    v_mul_f32 v158, v158, v50
    v_accvgpr_write_b32 a93, v158
    v_accvgpr_read_b32 v158, a94
    v_mul_f32 v158, v158, v50
    v_accvgpr_write_b32 a94, v158
    v_accvgpr_read_b32 v158, a95
    v_mul_f32 v158, v158, v50
    v_accvgpr_write_b32 a95, v158
    v_accvgpr_read_b32 v158, a96
    v_mul_f32 v158, v158, v51
    v_accvgpr_write_b32 a96, v158
    v_accvgpr_read_b32 v158, a97
    v_mul_f32 v158, v158, v51
    v_accvgpr_write_b32 a97, v158
    v_accvgpr_read_b32 v158, a98
    v_mul_f32 v158, v158, v51
    v_accvgpr_write_b32 a98, v158
    v_accvgpr_read_b32 v158, a99
    v_mul_f32 v158, v158, v51
    v_accvgpr_write_b32 a99, v158
    v_accvgpr_read_b32 v158, a100
    v_mul_f32 v158, v158, v51
    v_accvgpr_write_b32 a100, v158
    v_accvgpr_read_b32 v158, a101
    v_mul_f32 v158, v158, v51
    v_accvgpr_write_b32 a101, v158
    v_accvgpr_read_b32 v158, a102
    v_mul_f32 v158, v158, v51
    v_accvgpr_write_b32 a102, v158
    v_accvgpr_read_b32 v158, a103
    v_mul_f32 v158, v158, v51
    v_accvgpr_write_b32 a103, v158
    v_accvgpr_read_b32 v158, a104
    v_mul_f32 v158, v158, v51
    v_accvgpr_write_b32 a104, v158
    v_accvgpr_read_b32 v158, a105
    v_mul_f32 v158, v158, v51
    v_accvgpr_write_b32 a105, v158
    v_accvgpr_read_b32 v158, a106
    v_mul_f32 v158, v158, v51
    v_accvgpr_write_b32 a106, v158
    v_accvgpr_read_b32 v158, a107
    v_mul_f32 v158, v158, v51
    v_accvgpr_write_b32 a107, v158
    v_accvgpr_read_b32 v158, a108
    v_mul_f32 v158, v158, v51
    v_accvgpr_write_b32 a108, v158
    v_accvgpr_read_b32 v158, a109
    v_mul_f32 v158, v158, v51
    v_accvgpr_write_b32 a109, v158
    v_accvgpr_read_b32 v158, a110
    v_mul_f32 v158, v158, v51
    v_accvgpr_write_b32 a110, v158
    v_accvgpr_read_b32 v158, a111
    v_mul_f32 v158, v158, v51
    v_accvgpr_write_b32 a111, v158
    v_accvgpr_read_b32 v158, a112
    v_mul_f32 v158, v158, v51
    v_accvgpr_write_b32 a112, v158
    v_accvgpr_read_b32 v158, a113
    v_mul_f32 v158, v158, v51
    v_accvgpr_write_b32 a113, v158
    v_accvgpr_read_b32 v158, a114
    v_mul_f32 v158, v158, v51
    v_accvgpr_write_b32 a114, v158
    v_accvgpr_read_b32 v158, a115
    v_mul_f32 v158, v158, v51
    v_accvgpr_write_b32 a115, v158
    v_accvgpr_read_b32 v158, a116
    v_mul_f32 v158, v158, v51
    v_accvgpr_write_b32 a116, v158
    v_accvgpr_read_b32 v158, a117
    v_mul_f32 v158, v158, v51
    v_accvgpr_write_b32 a117, v158
    v_accvgpr_read_b32 v158, a118
    v_mul_f32 v158, v158, v51
    v_accvgpr_write_b32 a118, v158
    v_accvgpr_read_b32 v158, a119
    v_mul_f32 v158, v158, v51
    v_accvgpr_write_b32 a119, v158
    v_accvgpr_read_b32 v158, a120
    v_mul_f32 v158, v158, v51
    v_accvgpr_write_b32 a120, v158
    v_accvgpr_read_b32 v158, a121
    v_mul_f32 v158, v158, v51
    v_accvgpr_write_b32 a121, v158
    v_accvgpr_read_b32 v158, a122
    v_mul_f32 v158, v158, v51
    v_accvgpr_write_b32 a122, v158
    v_accvgpr_read_b32 v158, a123
    v_mul_f32 v158, v158, v51
    v_accvgpr_write_b32 a123, v158
    v_accvgpr_read_b32 v158, a124
    v_mul_f32 v158, v158, v51
    v_accvgpr_write_b32 a124, v158
    v_accvgpr_read_b32 v158, a125
    v_mul_f32 v158, v158, v51
    v_accvgpr_write_b32 a125, v158
    v_accvgpr_read_b32 v158, a126
    v_mul_f32 v158, v158, v51
    v_accvgpr_write_b32 a126, v158
    v_accvgpr_read_b32 v158, a127
    v_mul_f32 v158, v158, v51
    v_accvgpr_write_b32 a127, v158
    v_accvgpr_read_b32 v158, a128
    v_mul_f32 v158, v158, v52
    v_accvgpr_write_b32 a128, v158
    v_accvgpr_read_b32 v158, a129
    v_mul_f32 v158, v158, v52
    v_accvgpr_write_b32 a129, v158
    v_accvgpr_read_b32 v158, a130
    v_mul_f32 v158, v158, v52
    v_accvgpr_write_b32 a130, v158
    v_accvgpr_read_b32 v158, a131
    v_mul_f32 v158, v158, v52
    v_accvgpr_write_b32 a131, v158
    v_accvgpr_read_b32 v158, a132
    v_mul_f32 v158, v158, v52
    v_accvgpr_write_b32 a132, v158
    v_accvgpr_read_b32 v158, a133
    v_mul_f32 v158, v158, v52
    v_accvgpr_write_b32 a133, v158
    v_accvgpr_read_b32 v158, a134
    v_mul_f32 v158, v158, v52
    v_accvgpr_write_b32 a134, v158
    v_accvgpr_read_b32 v158, a135
    v_mul_f32 v158, v158, v52
    v_accvgpr_write_b32 a135, v158
    v_accvgpr_read_b32 v158, a136
    v_mul_f32 v158, v158, v52
    v_accvgpr_write_b32 a136, v158
    v_accvgpr_read_b32 v158, a137
    v_mul_f32 v158, v158, v52
    v_accvgpr_write_b32 a137, v158
    v_accvgpr_read_b32 v158, a138
    v_mul_f32 v158, v158, v52
    v_accvgpr_write_b32 a138, v158
    v_accvgpr_read_b32 v158, a139
    v_mul_f32 v158, v158, v52
    v_accvgpr_write_b32 a139, v158
    v_accvgpr_read_b32 v158, a140
    v_mul_f32 v158, v158, v52
    v_accvgpr_write_b32 a140, v158
    v_accvgpr_read_b32 v158, a141
    v_mul_f32 v158, v158, v52
    v_accvgpr_write_b32 a141, v158
    v_accvgpr_read_b32 v158, a142
    v_mul_f32 v158, v158, v52
    v_accvgpr_write_b32 a142, v158
    v_accvgpr_read_b32 v158, a143
    v_mul_f32 v158, v158, v52
    v_accvgpr_write_b32 a143, v158
    v_accvgpr_read_b32 v158, a144
    v_mul_f32 v158, v158, v52
    v_accvgpr_write_b32 a144, v158
    v_accvgpr_read_b32 v158, a145
    v_mul_f32 v158, v158, v52
    v_accvgpr_write_b32 a145, v158
    v_accvgpr_read_b32 v158, a146
    v_mul_f32 v158, v158, v52
    v_accvgpr_write_b32 a146, v158
    v_accvgpr_read_b32 v158, a147
    v_mul_f32 v158, v158, v52
    v_accvgpr_write_b32 a147, v158
    v_accvgpr_read_b32 v158, a148
    v_mul_f32 v158, v158, v52
    v_accvgpr_write_b32 a148, v158
    v_accvgpr_read_b32 v158, a149
    v_mul_f32 v158, v158, v52
    v_accvgpr_write_b32 a149, v158
    v_accvgpr_read_b32 v158, a150
    v_mul_f32 v158, v158, v52
    v_accvgpr_write_b32 a150, v158
    v_accvgpr_read_b32 v158, a151
    v_mul_f32 v158, v158, v52
    v_accvgpr_write_b32 a151, v158
    v_accvgpr_read_b32 v158, a152
    v_mul_f32 v158, v158, v52
    v_accvgpr_write_b32 a152, v158
    v_accvgpr_read_b32 v158, a153
    v_mul_f32 v158, v158, v52
    v_accvgpr_write_b32 a153, v158
    v_accvgpr_read_b32 v158, a154
    v_mul_f32 v158, v158, v52
    v_accvgpr_write_b32 a154, v158
    v_accvgpr_read_b32 v158, a155
    v_mul_f32 v158, v158, v52
    v_accvgpr_write_b32 a155, v158
    v_accvgpr_read_b32 v158, a156
    v_mul_f32 v158, v158, v52
    v_accvgpr_write_b32 a156, v158
    v_accvgpr_read_b32 v158, a157
    v_mul_f32 v158, v158, v52
    v_accvgpr_write_b32 a157, v158
    v_accvgpr_read_b32 v158, a158
    v_mul_f32 v158, v158, v52
    v_accvgpr_write_b32 a158, v158
    v_accvgpr_read_b32 v158, a159
    v_mul_f32 v158, v158, v52
    v_accvgpr_write_b32 a159, v158
    v_cvt_pk_bf16_f32 v200, v160, v161
    v_cvt_pk_bf16_f32 v201, v162, v163
    v_cvt_pk_bf16_f32 v202, v164, v165
    v_cvt_pk_bf16_f32 v203, v166, v167
    v_cvt_pk_bf16_f32 v204, v168, v169
    v_cvt_pk_bf16_f32 v205, v170, v171
    v_cvt_pk_bf16_f32 v206, v172, v173
    v_cvt_pk_bf16_f32 v207, v174, v175
    v_cvt_pk_bf16_f32 v208, v176, v177
    v_cvt_pk_bf16_f32 v209, v178, v179
    v_cvt_pk_bf16_f32 v210, v180, v181
    v_cvt_pk_bf16_f32 v211, v182, v183
    v_cvt_pk_bf16_f32 v212, v184, v185
    v_cvt_pk_bf16_f32 v213, v186, v187
    v_cvt_pk_bf16_f32 v214, v188, v189
    v_cvt_pk_bf16_f32 v215, v190, v191
    v_cvt_pk_bf16_f32 v216, v192, v193
    v_cvt_pk_bf16_f32 v217, v194, v195
    v_cvt_pk_bf16_f32 v218, v196, v197
    v_cvt_pk_bf16_f32 v219, v198, v199
    s_nop 1
    v_mfma_f32_16x16x32_bf16 a[0:3], v[116:119], v[200:203], a[0:3]
    v_mfma_f32_16x16x32_bf16 a[4:7], v[120:123], v[200:203], a[4:7]
    v_mfma_f32_16x16x32_bf16 a[8:11], v[124:127], v[200:203], a[8:11]
    v_mfma_f32_16x16x32_bf16 a[12:15], v[128:131], v[200:203], a[12:15]
    v_mfma_f32_16x16x32_bf16 a[16:19], v[132:135], v[200:203], a[16:19]
    v_mfma_f32_16x16x32_bf16 a[20:23], v[136:139], v[200:203], a[20:23]
    v_mfma_f32_16x16x32_bf16 a[24:27], v[140:143], v[200:203], a[24:27]
    v_mfma_f32_16x16x32_bf16 a[28:31], v[144:147], v[200:203], a[28:31]
    v_mfma_f32_16x16x32_bf16 a[32:35], v[116:119], v[204:207], a[32:35]
    v_mfma_f32_16x16x32_bf16 a[36:39], v[120:123], v[204:207], a[36:39]
    v_mfma_f32_16x16x32_bf16 a[40:43], v[124:127], v[204:207], a[40:43]
    v_mfma_f32_16x16x32_bf16 a[44:47], v[128:131], v[204:207], a[44:47]
    v_mfma_f32_16x16x32_bf16 a[48:51], v[132:135], v[204:207], a[48:51]
    v_mfma_f32_16x16x32_bf16 a[52:55], v[136:139], v[204:207], a[52:55]
    v_mfma_f32_16x16x32_bf16 a[56:59], v[140:143], v[204:207], a[56:59]
    v_mfma_f32_16x16x32_bf16 a[60:63], v[144:147], v[204:207], a[60:63]
    v_mfma_f32_16x16x32_bf16 a[64:67], v[116:119], v[208:211], a[64:67]
    v_mfma_f32_16x16x32_bf16 a[68:71], v[120:123], v[208:211], a[68:71]
    v_mfma_f32_16x16x32_bf16 a[72:75], v[124:127], v[208:211], a[72:75]
    v_mfma_f32_16x16x32_bf16 a[76:79], v[128:131], v[208:211], a[76:79]
    v_mfma_f32_16x16x32_bf16 a[80:83], v[132:135], v[208:211], a[80:83]
    v_mfma_f32_16x16x32_bf16 a[84:87], v[136:139], v[208:211], a[84:87]
    v_mfma_f32_16x16x32_bf16 a[88:91], v[140:143], v[208:211], a[88:91]
    v_mfma_f32_16x16x32_bf16 a[92:95], v[144:147], v[208:211], a[92:95]
    v_mfma_f32_16x16x32_bf16 a[96:99], v[116:119], v[212:215], a[96:99]
    v_mfma_f32_16x16x32_bf16 a[100:103], v[120:123], v[212:215], a[100:103]
    v_mfma_f32_16x16x32_bf16 a[104:107], v[124:127], v[212:215], a[104:107]
    v_mfma_f32_16x16x32_bf16 a[108:111], v[128:131], v[212:215], a[108:111]
    v_mfma_f32_16x16x32_bf16 a[112:115], v[132:135], v[212:215], a[112:115]
    v_mfma_f32_16x16x32_bf16 a[116:119], v[136:139], v[212:215], a[116:119]
    v_mfma_f32_16x16x32_bf16 a[120:123], v[140:143], v[212:215], a[120:123]
    v_mfma_f32_16x16x32_bf16 a[124:127], v[144:147], v[212:215], a[124:127]
    v_mfma_f32_16x16x32_bf16 a[128:131], v[116:119], v[216:219], a[128:131]
    v_mfma_f32_16x16x32_bf16 a[132:135], v[120:123], v[216:219], a[132:135]
    v_mfma_f32_16x16x32_bf16 a[136:139], v[124:127], v[216:219], a[136:139]
    v_mfma_f32_16x16x32_bf16 a[140:143], v[128:131], v[216:219], a[140:143]
    v_mfma_f32_16x16x32_bf16 a[144:147], v[132:135], v[216:219], a[144:147]
    v_mfma_f32_16x16x32_bf16 a[148:151], v[136:139], v[216:219], a[148:151]
    v_mfma_f32_16x16x32_bf16 a[152:155], v[140:143], v[216:219], a[152:155]
    v_mfma_f32_16x16x32_bf16 a[156:159], v[144:147], v[216:219], a[156:159]
    s_nop 7
    s_add_u32 s36, s36, 0x8000
    s_sub_u32 s38, s38, 1
    s_cmp_lg_u32 s38, 0
    s_cbranch_scc1 L_fb_loop
    s_barrier
    v_lshlrev_b32 v8, 2, v1
    s_mul_i32 s30, s27, 1280
    s_add_u32 s30, s30, 0
    v_add_u32 v9, s30, v8
    ds_write_b32 v9, v40 offset:0
    ds_write_b32 v9, v41 offset:256
    ds_write_b32 v9, v42 offset:512
    ds_write_b32 v9, v43 offset:768
    ds_write_b32 v9, v44 offset:1024
    s_waitcnt lgkmcnt(0)
    s_barrier
    ds_read_b32 v160, v8 offset:0
    ds_read_b32 v161, v8 offset:256
    ds_read_b32 v162, v8 offset:512
    ds_read_b32 v163, v8 offset:768
    ds_read_b32 v164, v8 offset:1024
    ds_read_b32 v165, v8 offset:1280
    ds_read_b32 v166, v8 offset:1536
    ds_read_b32 v167, v8 offset:1792
    ds_read_b32 v168, v8 offset:2048
    ds_read_b32 v169, v8 offset:2304
    ds_read_b32 v170, v8 offset:2560
    ds_read_b32 v171, v8 offset:2816
    ds_read_b32 v172, v8 offset:3072
    ds_read_b32 v173, v8 offset:3328
    ds_read_b32 v174, v8 offset:3584
    ds_read_b32 v175, v8 offset:3840
    ds_read_b32 v176, v8 offset:4096
    ds_read_b32 v177, v8 offset:4352
    ds_read_b32 v178, v8 offset:4608
    ds_read_b32 v179, v8 offset:4864
    s_waitcnt lgkmcnt(0)
    v_max3_f32 v148, v160, v165, v170
    v_max_f32 v148, v148, v175
    v_sub_f32 v48, v40, v148
    v_max3_f32 v149, v161, v166, v171
    v_max_f32 v149, v149, v176
    v_sub_f32 v49, v41, v149
    v_max3_f32 v150, v162, v167, v172
    v_max_f32 v150, v150, v177
    v_sub_f32 v50, v42, v150
    v_max3_f32 v151, v163, v168, v173
    v_max_f32 v151, v151, v178
    v_sub_f32 v51, v43, v151
    v_max3_f32 v152, v164, v169, v174
    v_max_f32 v152, v152, v179
    v_sub_f32 v52, v44, v152
    v_exp_f32 v48, v48
    v_exp_f32 v49, v49
    v_exp_f32 v50, v50
    v_exp_f32 v51, v51
    v_exp_f32 v52, v52
    s_nop 0
    v_mul_f32 v28, v28, v48
    v_mul_f32 v30, v30, v49
    v_mul_f32 v32, v32, v50
    v_mul_f32 v34, v34, v51
    v_mul_f32 v36, v36, v52
    v_mov_b32 v29, v28
    v_mov_b32 v31, v30
    v_mov_b32 v33, v32
    v_mov_b32 v35, v34
    v_mov_b32 v37, v36
    v_permlane32_swap_b32 v28, v29
    v_permlane32_swap_b32 v30, v31
    v_permlane32_swap_b32 v32, v33
    v_permlane32_swap_b32 v34, v35
    v_permlane32_swap_b32 v36, v37
    v_add_f32 v28, v28, v29
    v_add_f32 v30, v30, v31
    v_add_f32 v32, v32, v33
    v_add_f32 v34, v34, v35
    v_add_f32 v36, v36, v37
    v_mov_b32 v29, v28
    v_mov_b32 v31, v30
    v_mov_b32 v33, v32
    v_mov_b32 v35, v34
    v_mov_b32 v37, v36
    v_permlane16_swap_b32 v28, v29
    v_permlane16_swap_b32 v30, v31
    v_permlane16_swap_b32 v32, v33
    v_permlane16_swap_b32 v34, v35
    v_permlane16_swap_b32 v36, v37
    v_add_f32 v28, v28, v29
    v_add_f32 v30, v30, v31
    v_add_f32 v32, v32, v33
    v_add_f32 v34, v34, v35
    v_add_f32 v36, v36, v37
    v_accvgpr_read_b32 v158, a0
    v_mul_f32 v158, v158, v48
    v_accvgpr_write_b32 a0, v158
    v_accvgpr_read_b32 v158, a1
    v_mul_f32 v158, v158, v48
    v_accvgpr_write_b32 a1, v158
    v_accvgpr_read_b32 v158, a2
    v_mul_f32 v158, v158, v48
    v_accvgpr_write_b32 a2, v158
    v_accvgpr_read_b32 v158, a3
    v_mul_f32 v158, v158, v48
    v_accvgpr_write_b32 a3, v158
    v_accvgpr_read_b32 v158, a4
    v_mul_f32 v158, v158, v48
    v_accvgpr_write_b32 a4, v158
    v_accvgpr_read_b32 v158, a5
    v_mul_f32 v158, v158, v48
    v_accvgpr_write_b32 a5, v158
    v_accvgpr_read_b32 v158, a6
    v_mul_f32 v158, v158, v48
    v_accvgpr_write_b32 a6, v158
    v_accvgpr_read_b32 v158, a7
    v_mul_f32 v158, v158, v48
    v_accvgpr_write_b32 a7, v158
    v_accvgpr_read_b32 v158, a8
    v_mul_f32 v158, v158, v48
    v_accvgpr_write_b32 a8, v158
    v_accvgpr_read_b32 v158, a9
    v_mul_f32 v158, v158, v48
    v_accvgpr_write_b32 a9, v158
    v_accvgpr_read_b32 v158, a10
    v_mul_f32 v158, v158, v48
    v_accvgpr_write_b32 a10, v158
    v_accvgpr_read_b32 v158, a11
    v_mul_f32 v158, v158, v48
    v_accvgpr_write_b32 a11, v158
    v_accvgpr_read_b32 v158, a12
    v_mul_f32 v158, v158, v48
    v_accvgpr_write_b32 a12, v158
    v_accvgpr_read_b32 v158, a13
    v_mul_f32 v158, v158, v48
    v_accvgpr_write_b32 a13, v158
    v_accvgpr_read_b32 v158, a14
    v_mul_f32 v158, v158, v48
    v_accvgpr_write_b32 a14, v158
    v_accvgpr_read_b32 v158, a15
    v_mul_f32 v158, v158, v48
    v_accvgpr_write_b32 a15, v158
    v_accvgpr_read_b32 v158, a16
    v_mul_f32 v158, v158, v48
    v_accvgpr_write_b32 a16, v158
    v_accvgpr_read_b32 v158, a17
    v_mul_f32 v158, v158, v48
    v_accvgpr_write_b32 a17, v158
    v_accvgpr_read_b32 v158, a18
    v_mul_f32 v158, v158, v48
    v_accvgpr_write_b32 a18, v158
    v_accvgpr_read_b32 v158, a19
    v_mul_f32 v158, v158, v48
    v_accvgpr_write_b32 a19, v158
    v_accvgpr_read_b32 v158, a20
    v_mul_f32 v158, v158, v48
    v_accvgpr_write_b32 a20, v158
    v_accvgpr_read_b32 v158, a21
    v_mul_f32 v158, v158, v48
    v_accvgpr_write_b32 a21, v158
    v_accvgpr_read_b32 v158, a22
    v_mul_f32 v158, v158, v48
    v_accvgpr_write_b32 a22, v158
    v_accvgpr_read_b32 v158, a23
    v_mul_f32 v158, v158, v48
    v_accvgpr_write_b32 a23, v158
    v_accvgpr_read_b32 v158, a24
    v_mul_f32 v158, v158, v48
    v_accvgpr_write_b32 a24, v158
    v_accvgpr_read_b32 v158, a25
    v_mul_f32 v158, v158, v48
    v_accvgpr_write_b32 a25, v158
    v_accvgpr_read_b32 v158, a26
    v_mul_f32 v158, v158, v48
    v_accvgpr_write_b32 a26, v158
    v_accvgpr_read_b32 v158, a27
    v_mul_f32 v158, v158, v48
    v_accvgpr_write_b32 a27, v158
    v_accvgpr_read_b32 v158, a28
    v_mul_f32 v158, v158, v48
    v_accvgpr_write_b32 a28, v158
    v_accvgpr_read_b32 v158, a29
    v_mul_f32 v158, v158, v48
    v_accvgpr_write_b32 a29, v158
    v_accvgpr_read_b32 v158, a30
    v_mul_f32 v158, v158, v48
    v_accvgpr_write_b32 a30, v158
    v_accvgpr_read_b32 v158, a31
    v_mul_f32 v158, v158, v48
    v_accvgpr_write_b32 a31, v158
    v_accvgpr_read_b32 v158, a32
    v_mul_f32 v158, v158, v49
    v_accvgpr_write_b32 a32, v158
    v_accvgpr_read_b32 v158, a33
    v_mul_f32 v158, v158, v49
    v_accvgpr_write_b32 a33, v158
    v_accvgpr_read_b32 v158, a34
    v_mul_f32 v158, v158, v49
    v_accvgpr_write_b32 a34, v158
    v_accvgpr_read_b32 v158, a35
    v_mul_f32 v158, v158, v49
    v_accvgpr_write_b32 a35, v158
    v_accvgpr_read_b32 v158, a36
    v_mul_f32 v158, v158, v49
    v_accvgpr_write_b32 a36, v158
    v_accvgpr_read_b32 v158, a37
    v_mul_f32 v158, v158, v49
    v_accvgpr_write_b32 a37, v158
    v_accvgpr_read_b32 v158, a38
    v_mul_f32 v158, v158, v49
    v_accvgpr_write_b32 a38, v158
    v_accvgpr_read_b32 v158, a39
    v_mul_f32 v158, v158, v49
    v_accvgpr_write_b32 a39, v158
    v_accvgpr_read_b32 v158, a40
    v_mul_f32 v158, v158, v49
    v_accvgpr_write_b32 a40, v158
    v_accvgpr_read_b32 v158, a41
    v_mul_f32 v158, v158, v49
    v_accvgpr_write_b32 a41, v158
    v_accvgpr_read_b32 v158, a42
    v_mul_f32 v158, v158, v49
    v_accvgpr_write_b32 a42, v158
    v_accvgpr_read_b32 v158, a43
    v_mul_f32 v158, v158, v49
    v_accvgpr_write_b32 a43, v158
    v_accvgpr_read_b32 v158, a44
    v_mul_f32 v158, v158, v49
    v_accvgpr_write_b32 a44, v158
    v_accvgpr_read_b32 v158, a45
    v_mul_f32 v158, v158, v49
    v_accvgpr_write_b32 a45, v158
    v_accvgpr_read_b32 v158, a46
    v_mul_f32 v158, v158, v49
    v_accvgpr_write_b32 a46, v158
    v_accvgpr_read_b32 v158, a47
    v_mul_f32 v158, v158, v49
    v_accvgpr_write_b32 a47, v158
    v_accvgpr_read_b32 v158, a48
    v_mul_f32 v158, v158, v49
    v_accvgpr_write_b32 a48, v158
    v_accvgpr_read_b32 v158, a49
    v_mul_f32 v158, v158, v49
    v_accvgpr_write_b32 a49, v158
    v_accvgpr_read_b32 v158, a50
    v_mul_f32 v158, v158, v49
    v_accvgpr_write_b32 a50, v158
    v_accvgpr_read_b32 v158, a51
    v_mul_f32 v158, v158, v49
    v_accvgpr_write_b32 a51, v158
    v_accvgpr_read_b32 v158, a52
    v_mul_f32 v158, v158, v49
    v_accvgpr_write_b32 a52, v158
    v_accvgpr_read_b32 v158, a53
    v_mul_f32 v158, v158, v49
    v_accvgpr_write_b32 a53, v158
    v_accvgpr_read_b32 v158, a54
    v_mul_f32 v158, v158, v49
    v_accvgpr_write_b32 a54, v158
    v_accvgpr_read_b32 v158, a55
    v_mul_f32 v158, v158, v49
    v_accvgpr_write_b32 a55, v158
    v_accvgpr_read_b32 v158, a56
    v_mul_f32 v158, v158, v49
    v_accvgpr_write_b32 a56, v158
    v_accvgpr_read_b32 v158, a57
    v_mul_f32 v158, v158, v49
    v_accvgpr_write_b32 a57, v158
    v_accvgpr_read_b32 v158, a58
    v_mul_f32 v158, v158, v49
    v_accvgpr_write_b32 a58, v158
    v_accvgpr_read_b32 v158, a59
    v_mul_f32 v158, v158, v49
    v_accvgpr_write_b32 a59, v158
    v_accvgpr_read_b32 v158, a60
    v_mul_f32 v158, v158, v49
    v_accvgpr_write_b32 a60, v158
    v_accvgpr_read_b32 v158, a61
    v_mul_f32 v158, v158, v49
    v_accvgpr_write_b32 a61, v158
    v_accvgpr_read_b32 v158, a62
    v_mul_f32 v158, v158, v49
    v_accvgpr_write_b32 a62, v158
    v_accvgpr_read_b32 v158, a63
    v_mul_f32 v158, v158, v49
    v_accvgpr_write_b32 a63, v158
    v_accvgpr_read_b32 v158, a64
    v_mul_f32 v158, v158, v50
    v_accvgpr_write_b32 a64, v158
    v_accvgpr_read_b32 v158, a65
    v_mul_f32 v158, v158, v50
    v_accvgpr_write_b32 a65, v158
    v_accvgpr_read_b32 v158, a66
    v_mul_f32 v158, v158, v50
    v_accvgpr_write_b32 a66, v158
    v_accvgpr_read_b32 v158, a67
    v_mul_f32 v158, v158, v50
    v_accvgpr_write_b32 a67, v158
    v_accvgpr_read_b32 v158, a68
    v_mul_f32 v158, v158, v50
    v_accvgpr_write_b32 a68, v158
    v_accvgpr_read_b32 v158, a69
    v_mul_f32 v158, v158, v50
    v_accvgpr_write_b32 a69, v158
    v_accvgpr_read_b32 v158, a70
    v_mul_f32 v158, v158, v50
    v_accvgpr_write_b32 a70, v158
    v_accvgpr_read_b32 v158, a71
    v_mul_f32 v158, v158, v50
    v_accvgpr_write_b32 a71, v158
    v_accvgpr_read_b32 v158, a72
    v_mul_f32 v158, v158, v50
    v_accvgpr_write_b32 a72, v158
    v_accvgpr_read_b32 v158, a73
    v_mul_f32 v158, v158, v50
    v_accvgpr_write_b32 a73, v158
    v_accvgpr_read_b32 v158, a74
    v_mul_f32 v158, v158, v50
    v_accvgpr_write_b32 a74, v158
    v_accvgpr_read_b32 v158, a75
    v_mul_f32 v158, v158, v50
    v_accvgpr_write_b32 a75, v158
    v_accvgpr_read_b32 v158, a76
    v_mul_f32 v158, v158, v50
    v_accvgpr_write_b32 a76, v158
    v_accvgpr_read_b32 v158, a77
    v_mul_f32 v158, v158, v50
    v_accvgpr_write_b32 a77, v158
    v_accvgpr_read_b32 v158, a78
    v_mul_f32 v158, v158, v50
    v_accvgpr_write_b32 a78, v158
    v_accvgpr_read_b32 v158, a79
    v_mul_f32 v158, v158, v50
    v_accvgpr_write_b32 a79, v158
    v_accvgpr_read_b32 v158, a80
    v_mul_f32 v158, v158, v50
    v_accvgpr_write_b32 a80, v158
    v_accvgpr_read_b32 v158, a81
    v_mul_f32 v158, v158, v50
    v_accvgpr_write_b32 a81, v158
    v_accvgpr_read_b32 v158, a82
    v_mul_f32 v158, v158, v50
    v_accvgpr_write_b32 a82, v158
    v_accvgpr_read_b32 v158, a83
    v_mul_f32 v158, v158, v50
    v_accvgpr_write_b32 a83, v158
    v_accvgpr_read_b32 v158, a84
    v_mul_f32 v158, v158, v50
    v_accvgpr_write_b32 a84, v158
    v_accvgpr_read_b32 v158, a85
    v_mul_f32 v158, v158, v50
    v_accvgpr_write_b32 a85, v158
    v_accvgpr_read_b32 v158, a86
    v_mul_f32 v158, v158, v50
    v_accvgpr_write_b32 a86, v158
    v_accvgpr_read_b32 v158, a87
    v_mul_f32 v158, v158, v50
    v_accvgpr_write_b32 a87, v158
    v_accvgpr_read_b32 v158, a88
    v_mul_f32 v158, v158, v50
    v_accvgpr_write_b32 a88, v158
    v_accvgpr_read_b32 v158, a89
    v_mul_f32 v158, v158, v50
    v_accvgpr_write_b32 a89, v158
    v_accvgpr_read_b32 v158, a90
    v_mul_f32 v158, v158, v50
    v_accvgpr_write_b32 a90, v158
    v_accvgpr_read_b32 v158, a91
    v_mul_f32 v158, v158, v50
    v_accvgpr_write_b32 a91, v158
    v_accvgpr_read_b32 v158, a92
    v_mul_f32 v158, v158, v50
    v_accvgpr_write_b32 a92, v158
    v_accvgpr_read_b32 v158, a93
    v_mul_f32 v158, v158, v50
    v_accvgpr_write_b32 a93, v158
    v_accvgpr_read_b32 v158, a94
    v_mul_f32 v158, v158, v50
    v_accvgpr_write_b32 a94, v158
    v_accvgpr_read_b32 v158, a95
    v_mul_f32 v158, v158, v50
    v_accvgpr_write_b32 a95, v158
    v_accvgpr_read_b32 v158, a96
    v_mul_f32 v158, v158, v51
    v_accvgpr_write_b32 a96, v158
    v_accvgpr_read_b32 v158, a97
    v_mul_f32 v158, v158, v51
    v_accvgpr_write_b32 a97, v158
    v_accvgpr_read_b32 v158, a98
    v_mul_f32 v158, v158, v51
    v_accvgpr_write_b32 a98, v158
    v_accvgpr_read_b32 v158, a99
    v_mul_f32 v158, v158, v51
    v_accvgpr_write_b32 a99, v158
    v_accvgpr_read_b32 v158, a100
    v_mul_f32 v158, v158, v51
    v_accvgpr_write_b32 a100, v158
    v_accvgpr_read_b32 v158, a101
    v_mul_f32 v158, v158, v51
    v_accvgpr_write_b32 a101, v158
    v_accvgpr_read_b32 v158, a102
    v_mul_f32 v158, v158, v51
    v_accvgpr_write_b32 a102, v158
    v_accvgpr_read_b32 v158, a103
    v_mul_f32 v158, v158, v51
    v_accvgpr_write_b32 a103, v158
    v_accvgpr_read_b32 v158, a104
    v_mul_f32 v158, v158, v51
    v_accvgpr_write_b32 a104, v158
    v_accvgpr_read_b32 v158, a105
    v_mul_f32 v158, v158, v51
    v_accvgpr_write_b32 a105, v158
    v_accvgpr_read_b32 v158, a106
    v_mul_f32 v158, v158, v51
    v_accvgpr_write_b32 a106, v158
    v_accvgpr_read_b32 v158, a107
    v_mul_f32 v158, v158, v51
    v_accvgpr_write_b32 a107, v158
    v_accvgpr_read_b32 v158, a108
    v_mul_f32 v158, v158, v51
    v_accvgpr_write_b32 a108, v158
    v_accvgpr_read_b32 v158, a109
    v_mul_f32 v158, v158, v51
    v_accvgpr_write_b32 a109, v158
    v_accvgpr_read_b32 v158, a110
    v_mul_f32 v158, v158, v51
    v_accvgpr_write_b32 a110, v158
    v_accvgpr_read_b32 v158, a111
    v_mul_f32 v158, v158, v51
    v_accvgpr_write_b32 a111, v158
    v_accvgpr_read_b32 v158, a112
    v_mul_f32 v158, v158, v51
    v_accvgpr_write_b32 a112, v158
    v_accvgpr_read_b32 v158, a113
    v_mul_f32 v158, v158, v51
    v_accvgpr_write_b32 a113, v158
    v_accvgpr_read_b32 v158, a114
    v_mul_f32 v158, v158, v51
    v_accvgpr_write_b32 a114, v158
    v_accvgpr_read_b32 v158, a115
    v_mul_f32 v158, v158, v51
    v_accvgpr_write_b32 a115, v158
    v_accvgpr_read_b32 v158, a116
    v_mul_f32 v158, v158, v51
    v_accvgpr_write_b32 a116, v158
    v_accvgpr_read_b32 v158, a117
    v_mul_f32 v158, v158, v51
    v_accvgpr_write_b32 a117, v158
    v_accvgpr_read_b32 v158, a118
    v_mul_f32 v158, v158, v51
    v_accvgpr_write_b32 a118, v158
    v_accvgpr_read_b32 v158, a119
    v_mul_f32 v158, v158, v51
    v_accvgpr_write_b32 a119, v158
    v_accvgpr_read_b32 v158, a120
    v_mul_f32 v158, v158, v51
    v_accvgpr_write_b32 a120, v158
    v_accvgpr_read_b32 v158, a121
    v_mul_f32 v158, v158, v51
    v_accvgpr_write_b32 a121, v158
    v_accvgpr_read_b32 v158, a122
    v_mul_f32 v158, v158, v51
    v_accvgpr_write_b32 a122, v158
    v_accvgpr_read_b32 v158, a123
    v_mul_f32 v158, v158, v51
    v_accvgpr_write_b32 a123, v158
    v_accvgpr_read_b32 v158, a124
    v_mul_f32 v158, v158, v51
    v_accvgpr_write_b32 a124, v158
    v_accvgpr_read_b32 v158, a125
    v_mul_f32 v158, v158, v51
    v_accvgpr_write_b32 a125, v158
    v_accvgpr_read_b32 v158, a126
    v_mul_f32 v158, v158, v51
    v_accvgpr_write_b32 a126, v158
    v_accvgpr_read_b32 v158, a127
    v_mul_f32 v158, v158, v51
    v_accvgpr_write_b32 a127, v158
    v_accvgpr_read_b32 v158, a128
    v_mul_f32 v158, v158, v52
    v_accvgpr_write_b32 a128, v158
    v_accvgpr_read_b32 v158, a129
    v_mul_f32 v158, v158, v52
    v_accvgpr_write_b32 a129, v158
    v_accvgpr_read_b32 v158, a130
    v_mul_f32 v158, v158, v52
    v_accvgpr_write_b32 a130, v158
    v_accvgpr_read_b32 v158, a131
    v_mul_f32 v158, v158, v52
    v_accvgpr_write_b32 a131, v158
    v_accvgpr_read_b32 v158, a132
    v_mul_f32 v158, v158, v52
    v_accvgpr_write_b32 a132, v158
    v_accvgpr_read_b32 v158, a133
    v_mul_f32 v158, v158, v52
    v_accvgpr_write_b32 a133, v158
    v_accvgpr_read_b32 v158, a134
    v_mul_f32 v158, v158, v52
    v_accvgpr_write_b32 a134, v158
    v_accvgpr_read_b32 v158, a135
    v_mul_f32 v158, v158, v52
    v_accvgpr_write_b32 a135, v158
    v_accvgpr_read_b32 v158, a136
    v_mul_f32 v158, v158, v52
    v_accvgpr_write_b32 a136, v158
    v_accvgpr_read_b32 v158, a137
    v_mul_f32 v158, v158, v52
    v_accvgpr_write_b32 a137, v158
    v_accvgpr_read_b32 v158, a138
    v_mul_f32 v158, v158, v52
    v_accvgpr_write_b32 a138, v158
    v_accvgpr_read_b32 v158, a139
    v_mul_f32 v158, v158, v52
    v_accvgpr_write_b32 a139, v158
    v_accvgpr_read_b32 v158, a140
    v_mul_f32 v158, v158, v52
    v_accvgpr_write_b32 a140, v158
    v_accvgpr_read_b32 v158, a141
    v_mul_f32 v158, v158, v52
    v_accvgpr_write_b32 a141, v158
    v_accvgpr_read_b32 v158, a142
    v_mul_f32 v158, v158, v52
    v_accvgpr_write_b32 a142, v158
    v_accvgpr_read_b32 v158, a143
    v_mul_f32 v158, v158, v52
    v_accvgpr_write_b32 a143, v158
    v_accvgpr_read_b32 v158, a144
    v_mul_f32 v158, v158, v52
    v_accvgpr_write_b32 a144, v158
    v_accvgpr_read_b32 v158, a145
    v_mul_f32 v158, v158, v52
    v_accvgpr_write_b32 a145, v158
    v_accvgpr_read_b32 v158, a146
    v_mul_f32 v158, v158, v52
    v_accvgpr_write_b32 a146, v158
    v_accvgpr_read_b32 v158, a147
    v_mul_f32 v158, v158, v52
    v_accvgpr_write_b32 a147, v158
    v_accvgpr_read_b32 v158, a148
    v_mul_f32 v158, v158, v52
    v_accvgpr_write_b32 a148, v158
    v_accvgpr_read_b32 v158, a149
    v_mul_f32 v158, v158, v52
    v_accvgpr_write_b32 a149, v158
    v_accvgpr_read_b32 v158, a150
    v_mul_f32 v158, v158, v52
    v_accvgpr_write_b32 a150, v158
    v_accvgpr_read_b32 v158, a151
    v_mul_f32 v158, v158, v52
    v_accvgpr_write_b32 a151, v158
    v_accvgpr_read_b32 v158, a152
    v_mul_f32 v158, v158, v52
    v_accvgpr_write_b32 a152, v158
    v_accvgpr_read_b32 v158, a153
    v_mul_f32 v158, v158, v52
    v_accvgpr_write_b32 a153, v158
    v_accvgpr_read_b32 v158, a154
    v_mul_f32 v158, v158, v52
    v_accvgpr_write_b32 a154, v158
    v_accvgpr_read_b32 v158, a155
    v_mul_f32 v158, v158, v52
    v_accvgpr_write_b32 a155, v158
    v_accvgpr_read_b32 v158, a156
    v_mul_f32 v158, v158, v52
    v_accvgpr_write_b32 a156, v158
    v_accvgpr_read_b32 v158, a157
    v_mul_f32 v158, v158, v52
    v_accvgpr_write_b32 a157, v158
    v_accvgpr_read_b32 v158, a158
    v_mul_f32 v158, v158, v52
    v_accvgpr_write_b32 a158, v158
    v_accvgpr_read_b32 v158, a159
    v_mul_f32 v158, v158, v52
    v_accvgpr_write_b32 a159, v158
    v_mov_b32 v148, v28
    v_mov_b32 v152, v30
    v_mov_b32 v156, v32
    v_mov_b32 v160, v34
    v_mov_b32 v164, v36
    s_waitcnt vmcnt(0)
    s_barrier
    s_add_u32 s30, s27, 1
    s_and_b32 s30, s30, 3
    s_mul_i32 s30, s30, 30720
    s_add_u32 s30, s30, 0
    v_add_u32 v236, s30, v38
    s_add_u32 s30, s27, 2
    s_and_b32 s30, s30, 3
    s_mul_i32 s30, s30, 30720
    s_add_u32 s30, s30, 10240
    v_add_u32 v237, s30, v38
    s_add_u32 s30, s27, 3
    s_and_b32 s30, s30, 3
    s_mul_i32 s30, s30, 30720
    s_add_u32 s30, s30, 20480
    v_add_u32 v238, s30, v38
    v_lshlrev_b32 v8, 2, v1
    s_mul_i32 s30, s27, 1280
    s_add_u32 s30, s30, 122880
    v_add_u32 v239, s30, v8
    s_nop 7
    ds_write_b128 v236, a[8:11] offset:0
    ds_write_b128 v236, a[12:15] offset:1024
    ds_write_b128 v237, a[16:19] offset:0
    ds_write_b128 v237, a[20:23] offset:1024
    ds_write_b128 v238, a[24:27] offset:0
    ds_write_b128 v238, a[28:31] offset:1024
    v_accvgpr_read_b32 v176, a0
    v_accvgpr_read_b32 v177, a1
    v_accvgpr_read_b32 v178, a2
    v_accvgpr_read_b32 v179, a3
    v_accvgpr_read_b32 v180, a4
    v_accvgpr_read_b32 v181, a5
    v_accvgpr_read_b32 v182, a6
    v_accvgpr_read_b32 v183, a7
    ds_write_b128 v236, a[40:43] offset:2048
    ds_write_b128 v236, a[44:47] offset:3072
    ds_write_b128 v237, a[48:51] offset:2048
    ds_write_b128 v237, a[52:55] offset:3072
    ds_write_b128 v238, a[56:59] offset:2048
    ds_write_b128 v238, a[60:63] offset:3072
    v_accvgpr_read_b32 v184, a32
    v_accvgpr_read_b32 v185, a33
    v_accvgpr_read_b32 v186, a34
    v_accvgpr_read_b32 v187, a35
    v_accvgpr_read_b32 v188, a36
    v_accvgpr_read_b32 v189, a37
    v_accvgpr_read_b32 v190, a38
    v_accvgpr_read_b32 v191, a39
    ds_write_b128 v236, a[72:75] offset:4096
    ds_write_b128 v236, a[76:79] offset:5120
    ds_write_b128 v237, a[80:83] offset:4096
    ds_write_b128 v237, a[84:87] offset:5120
    ds_write_b128 v238, a[88:91] offset:4096
    ds_write_b128 v238, a[92:95] offset:5120
    v_accvgpr_read_b32 v192, a64
    v_accvgpr_read_b32 v193, a65
    v_accvgpr_read_b32 v194, a66
    v_accvgpr_read_b32 v195, a67
    v_accvgpr_read_b32 v196, a68
    v_accvgpr_read_b32 v197, a69
    v_accvgpr_read_b32 v198, a70
    v_accvgpr_read_b32 v199, a71
    ds_write_b128 v236, a[104:107] offset:6144
    ds_write_b128 v236, a[108:111] offset:7168
    ds_write_b128 v237, a[112:115] offset:6144
    ds_write_b128 v237, a[116:119] offset:7168
    ds_write_b128 v238, a[120:123] offset:6144
    ds_write_b128 v238, a[124:127] offset:7168
    v_accvgpr_read_b32 v200, a96
    v_accvgpr_read_b32 v201, a97
    v_accvgpr_read_b32 v202, a98
    v_accvgpr_read_b32 v203, a99
    v_accvgpr_read_b32 v204, a100
    v_accvgpr_read_b32 v205, a101
    v_accvgpr_read_b32 v206, a102
    v_accvgpr_read_b32 v207, a103
    ds_write_b128 v236, a[136:139] offset:8192
    ds_write_b128 v236, a[140:143] offset:9216
    ds_write_b128 v237, a[144:147] offset:8192
    ds_write_b128 v237, a[148:151] offset:9216
    ds_write_b128 v238, a[152:155] offset:8192
    ds_write_b128 v238, a[156:159] offset:9216
    v_accvgpr_read_b32 v208, a128
    v_accvgpr_read_b32 v209, a129
    v_accvgpr_read_b32 v210, a130
    v_accvgpr_read_b32 v211, a131
    v_accvgpr_read_b32 v212, a132
    v_accvgpr_read_b32 v213, a133
    v_accvgpr_read_b32 v214, a134
    v_accvgpr_read_b32 v215, a135
    ds_write_b32 v239, v148 offset:0
    ds_write_b32 v239, v152 offset:256
    ds_write_b32 v239, v156 offset:512
    ds_write_b32 v239, v160 offset:768
    ds_write_b32 v239, v164 offset:1024
    s_branch L_comb2
L_text_end:
    s_endpgm
.section .rodata,"a"
.p2align 6
.amdhsa_kernel standalone__gqa_block_cached__near_ridge_kernel
  .amdhsa_next_free_vgpr 512
  .amdhsa_next_free_sgpr 102
  .amdhsa_accum_offset 256
  .amdhsa_group_segment_fixed_size 0
  .amdhsa_kernarg_size 64
  .amdhsa_user_sgpr_count 2
  .amdhsa_user_sgpr_kernarg_segment_ptr 1
  .amdhsa_system_sgpr_workgroup_id_x 1
.end_amdhsa_kernel
```
